```python
import torch

def _softmax(x, axis=-1):
    return torch.softmax(x, dim=axis)
def _gelu(x):
    return torch.nn.functional.gelu(x, approximate="tanh")
def _silu(x):
    return torch.nn.functional.silu(x)
def _sigmoid(x):
    return torch.sigmoid(x)
def _layernorm(x, axis=-1, eps=1e-5):
    m = x.mean(dim=axis, keepdim=True)
    v = x.var(dim=axis, keepdim=True, unbiased=False)
    return (x - m) / torch.sqrt(v + eps)
def _scatter_add(tgt, idx, src, axis=0):
    return tgt.clone().index_add_(axis, idx, src)
def _segment_sum(src, seg, n):
    out = torch.zeros((n,) + src.shape[1:], dtype=src.dtype)
    return out.index_add_(0, seg, src)
def _pad(x, pw):
    flat = tuple(v for pair in reversed(pw) for v in pair)
    return torch.nn.functional.pad(x, flat)

kernel_name = 'standalone__gqa_block_cached__near_ridge'

def setup_inputs():

    _w = (lambda a: (lambda t: t.to(torch.bfloat16) if t.is_floating_point() else t)(torch.as_tensor(a)))
    B, Sq, D = 8, 32, 1024
    Hq, Hkv, Sk, Dh = 32, 4, 1024, 128
    assert Hq % Hkv == 0, (Hq, Hkv)
    return {
        "x": _w((lambda *s: torch.randn(*s, dtype=torch.bfloat16) * 0.8)(B, Sq, D)),
        "k_cache": _w((lambda *s: torch.randn(*s, dtype=torch.bfloat16) * 0.8)(B, Hkv, Sk, Dh)),
        "v_cache": _w((lambda *s: torch.randn(*s, dtype=torch.bfloat16) * 0.05)(B, Hkv, Sk, Dh)),
        "wq": _w((lambda *s: torch.randn(*s, dtype=torch.bfloat16) * 0.8)(D, Hq * Dh) * (D ** -0.5)),
        "wo": _w((lambda *s: torch.randn(*s, dtype=torch.bfloat16) * 0.05)(Hq * Dh, D) * ((Hq * Dh) ** -0.5)),
    }

def reference(x, k_cache, v_cache, wq, wo):
    B, Sq, D = x.shape
    Hq, Dh = 32, 128
    Hkv = k_cache.shape[1]
    rep = Hq // Hkv
    q = (lambda x, *d: x.permute(*d))((x @ wq).reshape(B, Sq, Hq, Dh), 0, 2, 1, 3)
    k = (lambda x, n, axis: torch.repeat_interleave(x, n, dim=axis))(k_cache, rep, axis=1)
    v = (lambda x, n, axis: torch.repeat_interleave(x, n, dim=axis))(v_cache, rep, axis=1)
    scores = torch.einsum("bhqd,bhkd->bhqk", q, k) * (Dh ** -0.5)
    p = _softmax(scores, axis=-1)
    o = torch.einsum("bhqk,bhkd->bhqd", p, v)
    return (lambda x, *d: x.permute(*d))(o, 0, 2, 1, 3).reshape(B, Sq, Hq * Dh) @ wo
```

```asm
; @launch grid=(256,1,1) block=(256,1,1) lds=163840
.amdgcn_target "amdgcn-amd-amdhsa--gfx950"

.text
.globl standalone__gqa_block_cached__near_ridge_kernel
.p2align 8
.type standalone__gqa_block_cached__near_ridge_kernel,@function
standalone__gqa_block_cached__near_ridge_kernel:

s_cmp_ge_u32 s2, 256
s_cbranch_scc1 L_end
s_load_dwordx2 s[20:21], s[0:1], 0
s_load_dwordx2 s[32:33], s[0:1], 24
s_load_dwordx2 s[48:49], s[0:1], 56
s_load_dwordx2 s[24:25], s[0:1], 8
s_load_dwordx2 s[28:29], s[0:1], 16
s_load_dwordx2 s[36:37], s[0:1], 32
s_load_dwordx2 s[40:41], s[0:1], 40
s_load_dwordx2 s[44:45], s[0:1], 48
s_lshr_b32 s56, s2, 3
s_getpc_b64 s[58:59]
s_min_u32 s60, s56, 16
s_lshl_b32 s60, s60, 10
v_lshl_add_u32 v38, v0, 2, s60
global_load_dword v72, v38, s[58:59]
v_lshrrev_b32 v31, 6, v0
v_and_b32 v0, 63, v0
s_and_b32 s58, s2, 7
v_readfirstlane_b32 s52, v31
s_lshr_b32 s55, s58, 1
s_and_b32 s58, s58, 1
s_lshl_b32 s58, s58, 2
s_and_b32 s59, s56, 3
s_add_u32 s53, s58, s59
s_lshr_b32 s58, s56, 2
s_lshl_b32 s59, s55, 3
s_add_u32 s54, s58, s59
s_mul_i32 s57, s52, 40960
s_mov_b32 s22, 524288
s_mov_b32 s23, 0x20000
s_mov_b32 s34, 8388608
s_mov_b32 s35, 0x20000
s_and_b32 s61, s56, 3
s_mul_i32 s61, s61, 2
s_mov_b32 s60, s61
s_and_b32 s61, s2, 1
s_xor_b32 s60, s60, s61
s_mov_b32 s61, s55
s_xor_b32 s60, s60, s61
s_and_b32 s60, s60, 3
v_lshlrev_b32 v1, 4, v0
v_lshrrev_b32 v34, 4, v0
v_and_b32 v35, 15, v0
v_lshrrev_b32 v36, 3, v0
v_and_b32 v37, 7, v0
v_xor_b32 v38, v37, v34
v_lshlrev_b32 v38, 4, v38
v_lshl_add_u32 v29, v36, 11, v38
v_xor_b32 v30, 64, v29
s_lshl_b32 s64, s53, 16
s_lshl_b32 s61, s52, 7
s_add_u32 s64, s64, s61
s_lshl_b32 s61, s60, 9
s_add_u32 s64, s64, s61
v_lshlrev_b32 v38, 2, v34
v_xor_b32 v38, v38, v35
v_lshlrev_b32 v38, 4, v38
v_lshl_add_u32 v18, v34, 13, v38
v_add_u32 v19, 31744, v18
v_add_u32 v20, 63488, v18
v_add_u32 v21, 95232, v18
s_lshl_b32 s62, s54, 8
s_lshl_b32 s61, s52, 19
s_add_u32 s62, s62, s61
s_lshl_b32 s61, s60, 21
s_add_u32 s62, s62, s61
s_waitcnt lgkmcnt(0)
s_add_u32 m0, s57, 0
s_xor_b32 s71, s64, 0
buffer_load_dwordx4 v29, s[20:23], s71 offen lds
s_add_u32 s71, s71, 15360
buffer_load_dwordx4 v30, s[20:23], s71 offen offset:1024 lds
s_add_u32 s71, s71, 15360
buffer_load_dwordx4 v29, s[20:23], s71 offen offset:2048 lds
s_add_u32 s71, s71, 15360
buffer_load_dwordx4 v30, s[20:23], s71 offen offset:3072 lds
s_add_u32 m0, s57, 4096
s_xor_b32 s71, s62, 0
buffer_load_dwordx4 v18, s[32:35], s71 offen lds
buffer_load_dwordx4 v19, s[32:35], s71 offen offset:1024 lds
buffer_load_dwordx4 v20, s[32:35], s71 offen offset:2048 lds
buffer_load_dwordx4 v21, s[32:35], s71 offen offset:3072 lds
v_lshlrev_b32 v38, 2, v34
v_xor_b32 v38, v38, v35
v_lshlrev_b32 v38, 4, v38
v_lshl_add_u32 v26, v34, 8, v38
v_and_b32 v38, 1, v34
v_lshlrev_b32 v38, 2, v38
v_xor_b32 v37, v37, v38
v_lshlrev_b32 v37, 4, v37
v_lshl_add_u32 v27, v36, 11, v37
s_lshl_b32 s73, s53, 5
s_add_u32 s73, s73, s54
s_mov_b32 s50, 268435456
s_mov_b32 s51, 0x20000
s_mov_b32 s26, 8388608
s_mov_b32 s27, 0x20000
s_mov_b32 s30, 8388608
s_mov_b32 s31, 0x20000
s_mov_b32 s38, 8388608
s_mov_b32 s39, 0x20000
s_mov_b32 s42, 524288
s_mov_b32 s43, 0x20000
s_mov_b32 s46, 256
s_mov_b32 s47, 0x20000
v_add_u32 v2, s57, v1
v_lshrrev_b32 v31, 5, v0
v_and_b32 v32, 31, v0
v_lshrrev_b32 v36, 1, v32
v_and_b32 v37, 7, v36
v_xor_b32 v37, v37, v31
v_and_b32 v38, 1, v0
v_lshl_add_u32 v37, v38, 3, v37
v_lshlrev_b32 v37, 4, v37
v_lshl_add_u32 v37, v36, 8, v37
v_add_u32 v120, s57, v37
v_xor_b32 v121, 32, v120
v_xor_b32 v122, 64, v120
v_xor_b32 v123, 96, v120
v_bfe_u32 v36, v0, 2, 2
v_bfe_u32 v37, v0, 4, 1
v_bfe_u32 v39, v0, 1, 1
v_lshlrev_b32 v38, 4, v38
v_lshl_add_u32 v38, v39, 3, v38
v_lshl_add_u32 v38, v37, 5, v38
v_lshl_add_u32 v39, v31, 3, v36
v_lshl_add_u32 v14, v39, 7, v38
v_lshrrev_b32 v33, 1, v36
s_and_b32 s58, s55, 1
v_xor_b32 v33, s58, v33
v_lshl_add_u32 v14, v33, 6, v14
s_and_b32 s58, s52, 1
s_lshl_b32 s58, s58, 3
s_lshr_b32 s59, s52, 1
s_lshl_b32 s59, s59, 5
s_or_b32 s58, s58, s59
v_xor_b32 v14, s58, v14
v_add_u32 v14, s57, v14
v_xor_b32 v15, 64, v14
v_lshl_add_u32 v38, v39, 8, v38
v_xor_b32 v36, s52, v36
v_lshl_add_u32 v38, v36, 6, v38
v_add_u32 v6, s57, v38
v_xor_b32 v7, 64, v6
v_xor_b32 v8, 128, v6
v_xor_b32 v9, 192, v6
s_lshr_b32 s58, s56, 1
s_lshr_b32 s59, s56, 4
s_xor_b32 s58, s58, s59
s_and_b32 s58, s58, 1
s_mul_i32 s58, s58, 3
s_lshl_b32 s59, s58, 9
s_xor_b32 s12, s64, s59
s_lshl_b32 s59, s58, 21
s_xor_b32 s13, s62, s59
s_add_u32 m0, s57, 8192
s_xor_b32 s71, s62, 131072
buffer_load_dwordx4 v18, s[32:35], s71 offen lds
buffer_load_dwordx4 v19, s[32:35], s71 offen offset:1024 lds
buffer_load_dwordx4 v20, s[32:35], s71 offen offset:2048 lds
buffer_load_dwordx4 v21, s[32:35], s71 offen offset:3072 lds
s_lshl_b32 s66, s73, 14
s_lshl_b32 s58, s52, 10
s_add_u32 s66, s66, s58
s_add_u32 s66, s66, 4194304
v_mov_b32 v44, -1
v_mov_b32 v45, -1
v_mov_b32 v46, -1
v_mov_b32 v47, -1
s_lshr_b32 s74, s73, 1
s_lshl_b32 s74, s74, 7
s_and_b32 s58, s54, 7
s_or_b32 s10, s58, s52
s_cmp_lg_u32 s10, 0
s_cbranch_scc1 L_norst
v_mov_b32 v38, 0
v_lshl_add_u32 v39, v0, 7, s74
s_mov_b64 exec, 15
buffer_store_dword v38, v39, s[48:51], 0 offen sc1
s_mov_b64 exec, -1
L_norst:
s_xor_b32 s58, s52, 1
s_mul_i32 s58, s58, 40960
v_add_u32 v3, s58, v1
s_xor_b32 s58, s52, 2
s_mul_i32 s58, s58, 40960
v_add_u32 v4, s58, v1
s_xor_b32 s58, s52, 3
s_mul_i32 s58, s58, 40960
v_add_u32 v5, s58, v1
v_lshrrev_b32 v36, 3, v0
v_and_b32 v37, 7, v0
v_xor_b32 v37, v37, v34
v_lshlrev_b32 v37, 4, v37
v_lshl_add_u32 v22, v36, 8, v37
v_xor_b32 v23, 64, v22
v_and_b32 v36, 0x13, v0
v_bfe_u32 v37, v0, 2, 1
v_bfe_u32 v38, v0, 3, 1
v_lshl_add_u32 v36, v37, 3, v36
v_lshl_add_u32 v36, v38, 2, v36
v_lshrrev_b32 v37, 1, v36
v_and_b32 v38, 7, v37
v_xor_b32 v38, v38, v31
s_and_b32 s58, s52, 1
s_lshl_b32 s58, s58, 2
v_xor_b32 v38, s58, v38
v_and_b32 v36, 1, v36
v_lshl_add_u32 v38, v36, 3, v38
v_lshlrev_b32 v38, 4, v38
v_lshl_add_u32 v38, v37, 8, v38
v_add_u32 v10, s57, v38
v_xor_b32 v11, 32, v10
v_xor_b32 v12, 64, v10
v_xor_b32 v13, 96, v10
s_lshl_b32 s63, s53, 2
s_add_u32 s63, s63, s55
s_lshl_b32 s63, s63, 18
s_lshl_b32 s58, s52, 16
s_add_u32 s63, s63, s58
s_lshr_b32 s58, s56, 2
s_and_b32 s58, s58, 3
s_lshl_b32 s58, s58, 14
s_add_u32 s63, s63, s58
s_lshr_b32 s58, s52, 1
s_lshl_b32 s58, s58, 7
s_add_u32 s75, s63, s58
s_and_b32 s14, s53, 3
s_lshl_b32 s14, s14, 1
s_bfe_u32 s58, s53, 0x10001
s_mul_i32 s58, s58, 4
s_and_b32 s59, s54, 7
s_mul_i32 s59, s59, 0
s_xor_b32 s58, s58, s59
s_and_b32 s59, s2, 1
s_mul_i32 s59, s59, 0
s_xor_b32 s58, s58, s59
s_and_b32 s58, s58, 7
s_lshl_b32 s59, s55, 2
s_add_u32 s59, s59, s52
s_lshl_b32 s59, s59, 3
s_add_u32 s58, s58, s59
s_lshl_b32 s67, s58, 16
s_and_b32 s59, s54, 7
s_lshr_b32 s60, s53, 2
s_lshl_b32 s60, s60, 3
s_add_u32 s59, s59, s60
s_lshl_b32 s65, s59, 7
s_add_u32 s67, s67, s65
s_lshr_b32 s59, s55, 1
s_add_u32 s68, s14, s59
s_lshl_b32 s59, s68, 16
s_add_u32 s65, s65, s59
s_lshl_b32 s68, s68, 18
s_lshl_b32 s58, s58, 11
s_add_u32 s68, s68, s58
s_add_u32 s68, s68, 1048576
s_xor_b32 s11, s68, 262144
s_and_b32 s58, s55, 1
s_lshl_b32 s58, s58, 6
s_add_u32 s65, s65, s58
s_lshr_b32 s58, s52, 1
s_lshl_b32 s58, s58, 5
s_add_u32 s65, s65, s58
s_and_b32 s58, s52, 1
s_lshl_b32 s58, s58, 3
s_add_u32 s65, s65, s58
s_mov_b32 s69, 0x3e0293ee
v_mov_b32 v124, 0x3f803f80
v_mov_b32 v125, 0x3f803f80
v_mov_b32 v126, 0x3f803f80
v_mov_b32 v127, 0x3f803f80
s_add_u32 m0, s57, 12288
s_xor_b32 s71, s62, 262144
buffer_load_dwordx4 v18, s[32:35], s71 offen lds
buffer_load_dwordx4 v19, s[32:35], s71 offen offset:1024 lds
buffer_load_dwordx4 v20, s[32:35], s71 offen offset:2048 lds
buffer_load_dwordx4 v21, s[32:35], s71 offen offset:3072 lds
s_add_u32 m0, s57, 16384
s_xor_b32 s71, s62, 393216
buffer_load_dwordx4 v18, s[32:35], s71 offen lds
buffer_load_dwordx4 v19, s[32:35], s71 offen offset:1024 lds
buffer_load_dwordx4 v20, s[32:35], s71 offen offset:2048 lds
buffer_load_dwordx4 v21, s[32:35], s71 offen offset:3072 lds
s_add_u32 m0, s57, 20480
s_xor_b32 s71, s12, 512
buffer_load_dwordx4 v29, s[20:23], s71 offen lds
s_add_u32 s71, s71, 15360
buffer_load_dwordx4 v30, s[20:23], s71 offen offset:1024 lds
s_add_u32 s71, s71, 15360
buffer_load_dwordx4 v29, s[20:23], s71 offen offset:2048 lds
s_add_u32 s71, s71, 15360
buffer_load_dwordx4 v30, s[20:23], s71 offen offset:3072 lds
s_add_u32 m0, s57, 24576
s_xor_b32 s71, s13, 2097152
buffer_load_dwordx4 v18, s[32:35], s71 offen lds
s_waitcnt vmcnt(17)
ds_read_b128 v[128:131], v120
ds_read_b128 v[132:135], v121
ds_read_b128 v[136:139], v122
ds_read_b128 v[140:143], v123
ds_read_b64_tr_b16 a[0:1], v6 offset:4096
ds_read_b64_tr_b16 a[2:3], v6 offset:5120
ds_read_b64_tr_b16 a[4:5], v7 offset:4096
ds_read_b64_tr_b16 a[6:7], v7 offset:5120
ds_read_b64_tr_b16 a[8:9], v8 offset:4096
ds_read_b64_tr_b16 a[10:11], v8 offset:5120
ds_read_b64_tr_b16 a[12:13], v9 offset:4096
ds_read_b64_tr_b16 a[14:15], v9 offset:5120
s_waitcnt lgkmcnt(0)
v_mfma_f32_32x32x16_bf16 v[48:63], a[0:3], v[128:131], 0
buffer_load_dwordx4 v19, s[32:35], s71 offen offset:1024 lds
buffer_load_dwordx4 v20, s[32:35], s71 offen offset:2048 lds
buffer_load_dwordx4 v21, s[32:35], s71 offen offset:3072 lds
s_add_u32 m0, s57, 28672
s_xor_b32 s71, s13, 2228224
buffer_load_dwordx4 v18, s[32:35], s71 offen lds
buffer_load_dwordx4 v19, s[32:35], s71 offen offset:1024 lds
buffer_load_dwordx4 v20, s[32:35], s71 offen offset:2048 lds
v_mfma_f32_32x32x16_bf16 a[64:79], a[4:7], v[128:131], 0
buffer_load_dwordx4 v21, s[32:35], s71 offen offset:3072 lds
s_add_u32 m0, s57, 32768
s_xor_b32 s71, s13, 2359296
buffer_load_dwordx4 v18, s[32:35], s71 offen lds
buffer_load_dwordx4 v19, s[32:35], s71 offen offset:1024 lds
s_waitcnt vmcnt(22)
ds_read_b64_tr_b16 a[32:33], v6 offset:8192
ds_read_b64_tr_b16 a[34:35], v6 offset:9216
ds_read_b64_tr_b16 a[36:37], v7 offset:8192
ds_read_b64_tr_b16 a[38:39], v7 offset:9216
ds_read_b64_tr_b16 a[40:41], v8 offset:8192
ds_read_b64_tr_b16 a[42:43], v8 offset:9216
ds_read_b64_tr_b16 a[44:45], v9 offset:8192
ds_read_b64_tr_b16 a[46:47], v9 offset:9216
v_mfma_f32_32x32x16_bf16 a[80:95], a[8:11], v[128:131], 0
v_mfma_f32_32x32x16_bf16 a[96:111], a[12:15], v[128:131], 0
s_waitcnt lgkmcnt(0)
v_mfma_f32_32x32x16_bf16 v[48:63], a[32:35], v[132:135], v[48:63]
buffer_load_dwordx4 v20, s[32:35], s71 offen offset:2048 lds
buffer_load_dwordx4 v21, s[32:35], s71 offen offset:3072 lds
s_add_u32 m0, s57, 4096
s_xor_b32 s71, s13, 2490368
buffer_load_dwordx4 v18, s[32:35], s71 offen lds
buffer_load_dwordx4 v19, s[32:35], s71 offen offset:1024 lds
v_mfma_f32_32x32x16_bf16 a[64:79], a[36:39], v[132:135], a[64:79]
s_waitcnt vmcnt(22)
ds_read_b64_tr_b16 a[0:1], v6 offset:12288
ds_read_b64_tr_b16 a[2:3], v6 offset:13312
ds_read_b64_tr_b16 a[4:5], v7 offset:12288
ds_read_b64_tr_b16 a[6:7], v7 offset:13312
ds_read_b64_tr_b16 a[8:9], v8 offset:12288
ds_read_b64_tr_b16 a[10:11], v8 offset:13312
ds_read_b64_tr_b16 a[12:13], v9 offset:12288
ds_read_b64_tr_b16 a[14:15], v9 offset:13312
v_mfma_f32_32x32x16_bf16 a[80:95], a[40:43], v[132:135], a[80:95]
v_mfma_f32_32x32x16_bf16 a[96:111], a[44:47], v[132:135], a[96:111]
s_waitcnt lgkmcnt(0)
v_mfma_f32_32x32x16_bf16 v[48:63], a[0:3], v[136:139], v[48:63]
buffer_load_dwordx4 v20, s[32:35], s71 offen offset:2048 lds
buffer_load_dwordx4 v21, s[32:35], s71 offen offset:3072 lds
s_add_u32 m0, s57, 0
s_xor_b32 s71, s12, 1024
buffer_load_dwordx4 v29, s[20:23], s71 offen lds
s_add_u32 s71, s71, 15360
buffer_load_dwordx4 v30, s[20:23], s71 offen offset:1024 lds
v_mfma_f32_32x32x16_bf16 a[64:79], a[4:7], v[136:139], a[64:79]
s_waitcnt vmcnt(22)
ds_read_b64_tr_b16 a[32:33], v6 offset:16384
ds_read_b64_tr_b16 a[34:35], v6 offset:17408
ds_read_b64_tr_b16 a[36:37], v7 offset:16384
ds_read_b64_tr_b16 a[38:39], v7 offset:17408
ds_read_b64_tr_b16 a[40:41], v8 offset:16384
ds_read_b64_tr_b16 a[42:43], v8 offset:17408
ds_read_b64_tr_b16 a[44:45], v9 offset:16384
ds_read_b64_tr_b16 a[46:47], v9 offset:17408
v_mfma_f32_32x32x16_bf16 a[80:95], a[8:11], v[136:139], a[80:95]
v_mfma_f32_32x32x16_bf16 a[96:111], a[12:15], v[136:139], a[96:111]
s_waitcnt lgkmcnt(0)
s_cmp_lg_u32 s10, 0
s_cbranch_scc1 L_nosig
s_lshl_b32 s58, s53, 2
s_add_u32 s58, s58, s55
s_lshl_b32 s58, s58, 3
v_mov_b32 v36, s58
v_mov_b32 v39, 1
s_mov_b64 exec, 1
buffer_store_dword v39, v36, s[44:47], 0 offen sc1
s_mov_b64 exec, -1
L_nosig:
v_mfma_f32_32x32x16_bf16 v[48:63], a[32:35], v[140:143], v[48:63]
s_add_u32 s71, s71, 15360
buffer_load_dwordx4 v29, s[20:23], s71 offen offset:2048 lds
s_add_u32 s71, s71, 15360
buffer_load_dwordx4 v30, s[20:23], s71 offen offset:3072 lds
s_add_u32 m0, s57, 8192
s_xor_b32 s71, s13, 4194304
buffer_load_dwordx4 v18, s[32:35], s71 offen lds
buffer_load_dwordx4 v19, s[32:35], s71 offen offset:1024 lds
v_mfma_f32_32x32x16_bf16 a[64:79], a[36:39], v[140:143], a[64:79]
s_waitcnt vmcnt(18)
ds_read_b128 v[144:147], v120 offset:20480
ds_read_b128 v[148:151], v121 offset:20480
ds_read_b128 v[152:155], v122 offset:20480
ds_read_b128 v[156:159], v123 offset:20480
ds_read_b64_tr_b16 a[0:1], v6 offset:24576
ds_read_b64_tr_b16 a[2:3], v6 offset:25600
ds_read_b64_tr_b16 a[4:5], v7 offset:24576
ds_read_b64_tr_b16 a[6:7], v7 offset:25600
ds_read_b64_tr_b16 a[8:9], v8 offset:24576
ds_read_b64_tr_b16 a[10:11], v8 offset:25600
ds_read_b64_tr_b16 a[12:13], v9 offset:24576
ds_read_b64_tr_b16 a[14:15], v9 offset:25600
v_mfma_f32_32x32x16_bf16 a[80:95], a[40:43], v[140:143], a[80:95]
v_mfma_f32_32x32x16_bf16 a[96:111], a[44:47], v[140:143], a[96:111]
s_waitcnt lgkmcnt(0)
v_mfma_f32_32x32x16_bf16 v[48:63], a[0:3], v[144:147], v[48:63]
buffer_load_dwordx4 v20, s[32:35], s71 offen offset:2048 lds
buffer_load_dwordx4 v21, s[32:35], s71 offen offset:3072 lds
s_add_u32 m0, s57, 12288
s_xor_b32 s71, s13, 4325376
buffer_load_dwordx4 v18, s[32:35], s71 offen lds
buffer_load_dwordx4 v19, s[32:35], s71 offen offset:1024 lds
buffer_load_dwordx4 v20, s[32:35], s71 offen offset:2048 lds
buffer_load_dwordx4 v21, s[32:35], s71 offen offset:3072 lds
v_mfma_f32_32x32x16_bf16 a[64:79], a[4:7], v[144:147], a[64:79]
s_add_u32 m0, s57, 16384
s_xor_b32 s71, s13, 4456448
buffer_load_dwordx4 v18, s[32:35], s71 offen lds
buffer_load_dwordx4 v19, s[32:35], s71 offen offset:1024 lds
s_waitcnt vmcnt(22)
ds_read_b64_tr_b16 a[32:33], v6 offset:28672
ds_read_b64_tr_b16 a[34:35], v6 offset:29696
ds_read_b64_tr_b16 a[36:37], v7 offset:28672
ds_read_b64_tr_b16 a[38:39], v7 offset:29696
ds_read_b64_tr_b16 a[40:41], v8 offset:28672
ds_read_b64_tr_b16 a[42:43], v8 offset:29696
ds_read_b64_tr_b16 a[44:45], v9 offset:28672
ds_read_b64_tr_b16 a[46:47], v9 offset:29696
v_mfma_f32_32x32x16_bf16 a[80:95], a[8:11], v[144:147], a[80:95]
v_mfma_f32_32x32x16_bf16 a[96:111], a[12:15], v[144:147], a[96:111]
s_waitcnt lgkmcnt(0)
v_mfma_f32_32x32x16_bf16 v[48:63], a[32:35], v[148:151], v[48:63]
buffer_load_dwordx4 v20, s[32:35], s71 offen offset:2048 lds
buffer_load_dwordx4 v21, s[32:35], s71 offen offset:3072 lds
s_add_u32 m0, s57, 24576
s_xor_b32 s71, s13, 4587520
buffer_load_dwordx4 v18, s[32:35], s71 offen lds
buffer_load_dwordx4 v19, s[32:35], s71 offen offset:1024 lds
v_mfma_f32_32x32x16_bf16 a[64:79], a[36:39], v[148:151], a[64:79]
s_waitcnt vmcnt(22)
ds_read_b64_tr_b16 a[0:1], v6 offset:32768
ds_read_b64_tr_b16 a[2:3], v6 offset:33792
ds_read_b64_tr_b16 a[4:5], v7 offset:32768
ds_read_b64_tr_b16 a[6:7], v7 offset:33792
ds_read_b64_tr_b16 a[8:9], v8 offset:32768
ds_read_b64_tr_b16 a[10:11], v8 offset:33792
ds_read_b64_tr_b16 a[12:13], v9 offset:32768
ds_read_b64_tr_b16 a[14:15], v9 offset:33792
v_mfma_f32_32x32x16_bf16 a[80:95], a[40:43], v[148:151], a[80:95]
v_mfma_f32_32x32x16_bf16 a[96:111], a[44:47], v[148:151], a[96:111]
s_waitcnt lgkmcnt(0)
v_mfma_f32_32x32x16_bf16 v[48:63], a[0:3], v[152:155], v[48:63]
buffer_load_dwordx4 v20, s[32:35], s71 offen offset:2048 lds
buffer_load_dwordx4 v21, s[32:35], s71 offen offset:3072 lds
s_add_u32 m0, s57, 20480
s_xor_b32 s71, s64, 1536
buffer_load_dwordx4 v29, s[20:23], s71 offen lds
s_add_u32 s71, s71, 15360
buffer_load_dwordx4 v30, s[20:23], s71 offen offset:1024 lds
v_mfma_f32_32x32x16_bf16 a[64:79], a[4:7], v[152:155], a[64:79]
s_waitcnt vmcnt(22)
ds_read_b64_tr_b16 a[32:33], v6 offset:4096
ds_read_b64_tr_b16 a[34:35], v6 offset:5120
ds_read_b64_tr_b16 a[36:37], v7 offset:4096
ds_read_b64_tr_b16 a[38:39], v7 offset:5120
ds_read_b64_tr_b16 a[40:41], v8 offset:4096
ds_read_b64_tr_b16 a[42:43], v8 offset:5120
ds_read_b64_tr_b16 a[44:45], v9 offset:4096
ds_read_b64_tr_b16 a[46:47], v9 offset:5120
v_mfma_f32_32x32x16_bf16 a[80:95], a[8:11], v[152:155], a[80:95]
v_mfma_f32_32x32x16_bf16 a[96:111], a[12:15], v[152:155], a[96:111]
s_waitcnt lgkmcnt(0)
v_mfma_f32_32x32x16_bf16 v[48:63], a[32:35], v[156:159], v[48:63]
s_add_u32 s71, s71, 15360
buffer_load_dwordx4 v29, s[20:23], s71 offen offset:2048 lds
s_add_u32 s71, s71, 15360
buffer_load_dwordx4 v30, s[20:23], s71 offen offset:3072 lds
s_add_u32 m0, s57, 28672
s_xor_b32 s71, s62, 6291456
buffer_load_dwordx4 v18, s[32:35], s71 offen lds
buffer_load_dwordx4 v19, s[32:35], s71 offen offset:1024 lds
v_mfma_f32_32x32x16_bf16 a[64:79], a[36:39], v[156:159], a[64:79]
s_waitcnt vmcnt(18)
ds_read_b128 v[128:131], v120
ds_read_b128 v[132:135], v121
ds_read_b128 v[136:139], v122
ds_read_b128 v[140:143], v123
ds_read_b64_tr_b16 a[0:1], v6 offset:8192
ds_read_b64_tr_b16 a[2:3], v6 offset:9216
ds_read_b64_tr_b16 a[4:5], v7 offset:8192
ds_read_b64_tr_b16 a[6:7], v7 offset:9216
ds_read_b64_tr_b16 a[8:9], v8 offset:8192
ds_read_b64_tr_b16 a[10:11], v8 offset:9216
ds_read_b64_tr_b16 a[12:13], v9 offset:8192
ds_read_b64_tr_b16 a[14:15], v9 offset:9216
v_mfma_f32_32x32x16_bf16 a[80:95], a[40:43], v[156:159], a[80:95]
v_mfma_f32_32x32x16_bf16 a[96:111], a[44:47], v[156:159], a[96:111]
s_waitcnt lgkmcnt(0)
v_mfma_f32_32x32x16_bf16 v[48:63], a[0:3], v[128:131], v[48:63]
buffer_load_dwordx4 v20, s[32:35], s71 offen offset:2048 lds
buffer_load_dwordx4 v21, s[32:35], s71 offen offset:3072 lds
s_add_u32 m0, s57, 32768
s_xor_b32 s71, s62, 6422528
buffer_load_dwordx4 v18, s[32:35], s71 offen lds
buffer_load_dwordx4 v19, s[32:35], s71 offen offset:1024 lds
buffer_load_dwordx4 v20, s[32:35], s71 offen offset:2048 lds
buffer_load_dwordx4 v21, s[32:35], s71 offen offset:3072 lds
v_mfma_f32_32x32x16_bf16 a[64:79], a[4:7], v[128:131], a[64:79]
s_add_u32 m0, s57, 4096
s_xor_b32 s71, s62, 6553600
buffer_load_dwordx4 v18, s[32:35], s71 offen lds
buffer_load_dwordx4 v19, s[32:35], s71 offen offset:1024 lds
s_waitcnt vmcnt(22)
ds_read_b64_tr_b16 a[32:33], v6 offset:12288
ds_read_b64_tr_b16 a[34:35], v6 offset:13312
ds_read_b64_tr_b16 a[36:37], v7 offset:12288
ds_read_b64_tr_b16 a[38:39], v7 offset:13312
ds_read_b64_tr_b16 a[40:41], v8 offset:12288
ds_read_b64_tr_b16 a[42:43], v8 offset:13312
ds_read_b64_tr_b16 a[44:45], v9 offset:12288
ds_read_b64_tr_b16 a[46:47], v9 offset:13312
v_mfma_f32_32x32x16_bf16 a[80:95], a[8:11], v[128:131], a[80:95]
v_mfma_f32_32x32x16_bf16 a[96:111], a[12:15], v[128:131], a[96:111]
s_waitcnt lgkmcnt(0)
v_mfma_f32_32x32x16_bf16 v[48:63], a[32:35], v[132:135], v[48:63]
buffer_load_dwordx4 v20, s[32:35], s71 offen offset:2048 lds
buffer_load_dwordx4 v21, s[32:35], s71 offen offset:3072 lds
s_add_u32 m0, s57, 8192
s_xor_b32 s71, s62, 6684672
buffer_load_dwordx4 v18, s[32:35], s71 offen lds
buffer_load_dwordx4 v19, s[32:35], s71 offen offset:1024 lds
v_mfma_f32_32x32x16_bf16 a[64:79], a[36:39], v[132:135], a[64:79]
s_waitcnt vmcnt(22)
ds_read_b64_tr_b16 a[0:1], v6 offset:16384
ds_read_b64_tr_b16 a[2:3], v6 offset:17408
ds_read_b64_tr_b16 a[4:5], v7 offset:16384
ds_read_b64_tr_b16 a[6:7], v7 offset:17408
ds_read_b64_tr_b16 a[8:9], v8 offset:16384
ds_read_b64_tr_b16 a[10:11], v8 offset:17408
ds_read_b64_tr_b16 a[12:13], v9 offset:16384
ds_read_b64_tr_b16 a[14:15], v9 offset:17408
v_mfma_f32_32x32x16_bf16 a[80:95], a[40:43], v[132:135], a[80:95]
v_mfma_f32_32x32x16_bf16 a[96:111], a[44:47], v[132:135], a[96:111]
s_waitcnt lgkmcnt(0)
v_mfma_f32_32x32x16_bf16 v[48:63], a[0:3], v[136:139], v[48:63]
buffer_load_dwordx4 v20, s[32:35], s71 offen offset:2048 lds
buffer_load_dwordx4 v21, s[32:35], s71 offen offset:3072 lds
s_add_u32 m0, s57, 0
s_xor_b32 s71, s75, 0
buffer_load_dwordx4 v22, s[24:27], s71 offen lds
s_add_u32 s71, s71, 1024
buffer_load_dwordx4 v23, s[24:27], s71 offen offset:1024 lds
v_mfma_f32_32x32x16_bf16 a[64:79], a[4:7], v[136:139], a[64:79]
s_waitcnt vmcnt(22)
ds_read_b64_tr_b16 a[32:33], v6 offset:24576
ds_read_b64_tr_b16 a[34:35], v6 offset:25600
ds_read_b64_tr_b16 a[36:37], v7 offset:24576
ds_read_b64_tr_b16 a[38:39], v7 offset:25600
ds_read_b64_tr_b16 a[40:41], v8 offset:24576
ds_read_b64_tr_b16 a[42:43], v8 offset:25600
ds_read_b64_tr_b16 a[44:45], v9 offset:24576
ds_read_b64_tr_b16 a[46:47], v9 offset:25600
v_mfma_f32_32x32x16_bf16 a[80:95], a[8:11], v[136:139], a[80:95]
v_mfma_f32_32x32x16_bf16 a[96:111], a[12:15], v[136:139], a[96:111]
s_waitcnt lgkmcnt(0)
v_mfma_f32_32x32x16_bf16 v[48:63], a[32:35], v[140:143], v[48:63]
s_add_u32 s71, s71, 1024
buffer_load_dwordx4 v22, s[24:27], s71 offen offset:2048 lds
s_add_u32 s71, s71, 1024
buffer_load_dwordx4 v23, s[24:27], s71 offen offset:3072 lds
s_add_u32 m0, s57, 12288
s_xor_b32 s71, s75, 128
buffer_load_dwordx4 v22, s[24:27], s71 offen lds
s_add_u32 s71, s71, 1024
buffer_load_dwordx4 v23, s[24:27], s71 offen offset:1024 lds
v_mfma_f32_32x32x16_bf16 a[64:79], a[36:39], v[140:143], a[64:79]
s_waitcnt vmcnt(18)
ds_read_b128 v[144:147], v120 offset:20480
ds_read_b128 v[148:151], v121 offset:20480
ds_read_b128 v[152:155], v122 offset:20480
ds_read_b128 v[156:159], v123 offset:20480
ds_read_b64_tr_b16 a[0:1], v6 offset:28672
ds_read_b64_tr_b16 a[2:3], v6 offset:29696
ds_read_b64_tr_b16 a[4:5], v7 offset:28672
ds_read_b64_tr_b16 a[6:7], v7 offset:29696
ds_read_b64_tr_b16 a[8:9], v8 offset:28672
ds_read_b64_tr_b16 a[10:11], v8 offset:29696
ds_read_b64_tr_b16 a[12:13], v9 offset:28672
ds_read_b64_tr_b16 a[14:15], v9 offset:29696
v_mfma_f32_32x32x16_bf16 a[80:95], a[40:43], v[140:143], a[80:95]
v_mfma_f32_32x32x16_bf16 a[96:111], a[44:47], v[140:143], a[96:111]
s_waitcnt lgkmcnt(0)
v_mfma_f32_32x32x16_bf16 v[48:63], a[0:3], v[144:147], v[48:63]
v_mfma_f32_32x32x16_bf16 a[64:79], a[4:7], v[144:147], a[64:79]
s_waitcnt vmcnt(14)
ds_read_b64_tr_b16 a[32:33], v6 offset:32768
ds_read_b64_tr_b16 a[34:35], v6 offset:33792
ds_read_b64_tr_b16 a[36:37], v7 offset:32768
ds_read_b64_tr_b16 a[38:39], v7 offset:33792
ds_read_b64_tr_b16 a[40:41], v8 offset:32768
ds_read_b64_tr_b16 a[42:43], v8 offset:33792
ds_read_b64_tr_b16 a[44:45], v9 offset:32768
ds_read_b64_tr_b16 a[46:47], v9 offset:33792
v_mfma_f32_32x32x16_bf16 a[80:95], a[8:11], v[144:147], a[80:95]
v_mfma_f32_32x32x16_bf16 a[96:111], a[12:15], v[144:147], a[96:111]
s_waitcnt lgkmcnt(0)
v_mfma_f32_32x32x16_bf16 v[48:63], a[32:35], v[148:151], v[48:63]
v_mfma_f32_32x32x16_bf16 a[64:79], a[36:39], v[148:151], a[64:79]
s_waitcnt vmcnt(10)
ds_read_b64_tr_b16 a[0:1], v6 offset:4096
ds_read_b64_tr_b16 a[2:3], v6 offset:5120
ds_read_b64_tr_b16 a[4:5], v7 offset:4096
ds_read_b64_tr_b16 a[6:7], v7 offset:5120
ds_read_b64_tr_b16 a[8:9], v8 offset:4096
ds_read_b64_tr_b16 a[10:11], v8 offset:5120
ds_read_b64_tr_b16 a[12:13], v9 offset:4096
ds_read_b64_tr_b16 a[14:15], v9 offset:5120
v_mfma_f32_32x32x16_bf16 a[80:95], a[40:43], v[148:151], a[80:95]
v_mfma_f32_32x32x16_bf16 a[96:111], a[44:47], v[148:151], a[96:111]
s_waitcnt lgkmcnt(0)
v_mfma_f32_32x32x16_bf16 v[48:63], a[0:3], v[152:155], v[48:63]
v_mfma_f32_32x32x16_bf16 a[64:79], a[4:7], v[152:155], a[64:79]
s_waitcnt vmcnt(6)
ds_read_b64_tr_b16 a[32:33], v6 offset:8192
ds_read_b64_tr_b16 a[34:35], v6 offset:9216
ds_read_b64_tr_b16 a[36:37], v7 offset:8192
ds_read_b64_tr_b16 a[38:39], v7 offset:9216
ds_read_b64_tr_b16 a[40:41], v8 offset:8192
ds_read_b64_tr_b16 a[42:43], v8 offset:9216
ds_read_b64_tr_b16 a[44:45], v9 offset:8192
ds_read_b64_tr_b16 a[46:47], v9 offset:9216
v_mfma_f32_32x32x16_bf16 a[80:95], a[8:11], v[152:155], a[80:95]
v_mfma_f32_32x32x16_bf16 a[96:111], a[12:15], v[152:155], a[96:111]
s_waitcnt lgkmcnt(0)
v_mfma_f32_32x32x16_bf16 v[48:63], a[32:35], v[156:159], v[48:63]
v_mfma_f32_32x32x16_bf16 a[64:79], a[36:39], v[156:159], a[64:79]
v_mfma_f32_32x32x16_bf16 a[80:95], a[40:43], v[156:159], a[80:95]
v_mfma_f32_32x32x16_bf16 a[96:111], a[44:47], v[156:159], a[96:111]
s_add_u32 s71, s71, 1024
buffer_load_dwordx4 v22, s[24:27], s71 offen offset:2048 lds
s_add_u32 s71, s71, 1024
buffer_load_dwordx4 v23, s[24:27], s71 offen offset:3072 lds
s_nop 5
ds_write_b128 v2, a[64:67] offset:16384
ds_write_b128 v2, a[68:71] offset:17408
s_add_u32 m0, s57, 20480
s_xor_b32 s71, s75, 8192
buffer_load_dwordx4 v22, s[24:27], s71 offen lds
ds_write_b128 v2, a[72:75] offset:18432
ds_write_b128 v2, a[76:79] offset:19456
s_add_u32 s71, s71, 1024
buffer_load_dwordx4 v23, s[24:27], s71 offen offset:1024 lds
ds_write_b128 v2, a[80:83] offset:24576
ds_write_b128 v2, a[84:87] offset:25600
s_add_u32 s71, s71, 1024
buffer_load_dwordx4 v22, s[24:27], s71 offen offset:2048 lds
ds_write_b128 v2, a[88:91] offset:26624
ds_write_b128 v2, a[92:95] offset:27648
s_add_u32 s71, s71, 1024
buffer_load_dwordx4 v23, s[24:27], s71 offen offset:3072 lds
ds_write_b128 v2, a[96:99] offset:28672
ds_write_b128 v2, a[100:103] offset:29696
s_add_u32 m0, s57, 32768
s_xor_b32 s71, s75, 8320
buffer_load_dwordx4 v22, s[24:27], s71 offen lds
ds_write_b128 v2, a[104:107] offset:30720
ds_write_b128 v2, a[108:111] offset:31744
s_add_u32 s71, s71, 1024
buffer_load_dwordx4 v23, s[24:27], s71 offen offset:1024 lds
s_waitcnt lgkmcnt(0)
s_barrier
ds_read_b128 v[72:75], v3 offset:16384
ds_read_b128 v[76:79], v3 offset:17408
ds_read_b128 v[80:83], v3 offset:18432
ds_read_b128 v[84:87], v3 offset:19456
s_add_u32 s71, s71, 1024
buffer_load_dwordx4 v22, s[24:27], s71 offen offset:2048 lds
ds_read_b128 v[88:91], v4 offset:24576
ds_read_b128 v[92:95], v4 offset:25600
ds_read_b128 v[96:99], v4 offset:26624
ds_read_b128 v[100:103], v4 offset:27648
s_add_u32 s71, s71, 1024
buffer_load_dwordx4 v23, s[24:27], s71 offen offset:3072 lds
ds_read_b128 v[104:107], v5 offset:28672
ds_read_b128 v[108:111], v5 offset:29696
ds_read_b128 v[112:115], v5 offset:30720
ds_read_b128 v[116:119], v5 offset:31744
s_add_u32 m0, s57, 4096
s_xor_b32 s71, s75, 16384
buffer_load_dwordx4 v22, s[24:27], s71 offen lds
s_waitcnt lgkmcnt(8)
v_pk_add_f32 v[48:49], v[48:49], v[72:73]
v_pk_add_f32 v[50:51], v[50:51], v[74:75]
v_pk_add_f32 v[52:53], v[52:53], v[76:77]
v_pk_add_f32 v[54:55], v[54:55], v[78:79]
s_add_u32 s71, s71, 1024
buffer_load_dwordx4 v23, s[24:27], s71 offen offset:1024 lds
v_pk_add_f32 v[56:57], v[56:57], v[80:81]
v_pk_add_f32 v[58:59], v[58:59], v[82:83]
v_pk_add_f32 v[60:61], v[60:61], v[84:85]
v_pk_add_f32 v[62:63], v[62:63], v[86:87]
s_add_u32 s71, s71, 1024
buffer_load_dwordx4 v22, s[24:27], s71 offen offset:2048 lds
s_waitcnt lgkmcnt(4)
v_pk_add_f32 v[48:49], v[48:49], v[88:89]
v_pk_add_f32 v[50:51], v[50:51], v[90:91]
v_pk_add_f32 v[52:53], v[52:53], v[92:93]
v_pk_add_f32 v[54:55], v[54:55], v[94:95]
s_add_u32 s71, s71, 1024
buffer_load_dwordx4 v23, s[24:27], s71 offen offset:3072 lds
v_pk_add_f32 v[56:57], v[56:57], v[96:97]
v_pk_add_f32 v[58:59], v[58:59], v[98:99]
v_pk_add_f32 v[60:61], v[60:61], v[100:101]
v_pk_add_f32 v[62:63], v[62:63], v[102:103]
s_add_u32 m0, s57, 8192
s_xor_b32 s71, s75, 16512
buffer_load_dwordx4 v22, s[24:27], s71 offen lds
s_waitcnt lgkmcnt(0)
v_pk_add_f32 v[48:49], v[48:49], v[104:105]
v_pk_add_f32 v[50:51], v[50:51], v[106:107]
v_pk_add_f32 v[52:53], v[52:53], v[108:109]
v_pk_add_f32 v[54:55], v[54:55], v[110:111]
s_add_u32 s71, s71, 1024
buffer_load_dwordx4 v23, s[24:27], s71 offen offset:1024 lds
v_pk_add_f32 v[56:57], v[56:57], v[112:113]
v_pk_add_f32 v[58:59], v[58:59], v[114:115]
v_pk_add_f32 v[60:61], v[60:61], v[116:117]
v_pk_add_f32 v[62:63], v[62:63], v[118:119]
s_add_u32 s71, s71, 1024
buffer_load_dwordx4 v22, s[24:27], s71 offen offset:2048 lds
v_cvt_pk_bf16_f32 v64, v48, v49
v_cvt_pk_bf16_f32 v65, v50, v51
v_cvt_pk_bf16_f32 v66, v52, v53
v_cvt_pk_bf16_f32 v67, v54, v55
v_cvt_pk_bf16_f32 v68, v56, v57
v_cvt_pk_bf16_f32 v69, v58, v59
v_cvt_pk_bf16_f32 v70, v60, v61
v_cvt_pk_bf16_f32 v71, v62, v63
ds_write_b128 v2, v[64:67] offset:36864
ds_write_b128 v2, v[68:71] offset:37888
s_add_u32 s71, s71, 1024
buffer_load_dwordx4 v23, s[24:27], s71 offen offset:3072 lds
s_waitcnt lgkmcnt(0)
s_barrier
ds_read_b128 a[112:115], v3 offset:36864
ds_read_b128 a[116:119], v3 offset:37888
ds_read_b128 a[120:123], v4 offset:36864
ds_read_b128 a[124:127], v4 offset:37888
ds_read_b128 a[128:131], v5 offset:36864
ds_read_b128 a[132:135], v5 offset:37888
s_waitcnt vmcnt(16)
ds_read_b128 a[0:3], v10
ds_read_b128 a[4:7], v11
ds_read_b128 a[8:11], v12
ds_read_b128 a[12:15], v13
ds_read_b128 a[16:19], v10 offset:12288
ds_read_b128 a[20:23], v11 offset:12288
ds_read_b128 a[24:27], v12 offset:12288
ds_read_b128 a[28:31], v13 offset:12288
s_waitcnt lgkmcnt(8)
s_waitcnt lgkmcnt(0)
v_mfma_f32_32x32x16_bf16 v[128:143], a[0:3], v[64:67], 0
s_add_u32 m0, s57, 16384
s_xor_b32 s71, s75, 24576
buffer_load_dwordx4 v22, s[24:27], s71 offen lds
v_mfma_f32_32x32x16_bf16 v[128:143], a[4:7], v[68:71], v[128:143]
s_add_u32 s71, s71, 1024
buffer_load_dwordx4 v23, s[24:27], s71 offen offset:1024 lds
v_mfma_f32_32x32x16_bf16 v[128:143], a[8:11], a[112:115], v[128:143]
s_add_u32 s71, s71, 1024
buffer_load_dwordx4 v22, s[24:27], s71 offen offset:2048 lds
v_mfma_f32_32x32x16_bf16 v[128:143], a[12:15], a[116:119], v[128:143]
s_add_u32 s71, s71, 1024
buffer_load_dwordx4 v23, s[24:27], s71 offen offset:3072 lds
s_waitcnt vmcnt(12)
ds_read_b128 a[32:35], v10 offset:20480
ds_read_b128 a[36:39], v11 offset:20480
ds_read_b128 a[40:43], v12 offset:20480
ds_read_b128 a[44:47], v13 offset:20480
ds_read_b128 a[48:51], v10 offset:32768
ds_read_b128 a[52:55], v11 offset:32768
ds_read_b128 a[56:59], v12 offset:32768
ds_read_b128 a[60:63], v13 offset:32768
v_mfma_f32_32x32x16_bf16 v[128:143], a[16:19], a[120:123], v[128:143]
s_add_u32 m0, s57, 24576
s_xor_b32 s71, s75, 24704
buffer_load_dwordx4 v22, s[24:27], s71 offen lds
v_mfma_f32_32x32x16_bf16 v[128:143], a[20:23], a[124:127], v[128:143]
s_add_u32 s71, s71, 1024
buffer_load_dwordx4 v23, s[24:27], s71 offen offset:1024 lds
v_mfma_f32_32x32x16_bf16 v[128:143], a[24:27], a[128:131], v[128:143]
s_add_u32 s71, s71, 1024
buffer_load_dwordx4 v22, s[24:27], s71 offen offset:2048 lds
v_mfma_f32_32x32x16_bf16 v[128:143], a[28:31], a[132:135], v[128:143]
s_add_u32 s71, s71, 1024
buffer_load_dwordx4 v23, s[24:27], s71 offen offset:3072 lds
s_add_u32 m0, s57, 28672
s_xor_b32 s71, s75, 32768
buffer_load_dwordx4 v22, s[24:27], s71 offen lds
s_add_u32 s71, s71, 1024
buffer_load_dwordx4 v23, s[24:27], s71 offen offset:1024 lds
s_add_u32 s71, s71, 1024
buffer_load_dwordx4 v22, s[24:27], s71 offen offset:2048 lds
s_waitcnt lgkmcnt(0)
v_mfma_f32_32x32x16_bf16 v[144:159], a[32:35], v[64:67], 0
s_add_u32 s71, s71, 1024
buffer_load_dwordx4 v23, s[24:27], s71 offen offset:3072 lds
v_mfma_f32_32x32x16_bf16 v[144:159], a[36:39], v[68:71], v[144:159]
s_add_u32 m0, s57, 0
s_xor_b32 s71, s75, 32896
buffer_load_dwordx4 v22, s[24:27], s71 offen lds
v_mfma_f32_32x32x16_bf16 v[144:159], a[40:43], a[112:115], v[144:159]
s_add_u32 s71, s71, 1024
buffer_load_dwordx4 v23, s[24:27], s71 offen offset:1024 lds
v_max3_f32 v43, v128, v129, v130
v_mfma_f32_32x32x16_bf16 v[144:159], a[44:47], a[116:119], v[144:159]
s_add_u32 s71, s71, 1024
buffer_load_dwordx4 v22, s[24:27], s71 offen offset:2048 lds
s_waitcnt vmcnt(15)
ds_read_b128 a[0:3], v10 offset:4096
ds_read_b128 a[4:7], v11 offset:4096
ds_read_b128 a[8:11], v12 offset:4096
ds_read_b128 a[12:15], v13 offset:4096
ds_read_b128 a[16:19], v10 offset:8192
ds_read_b128 a[20:23], v11 offset:8192
ds_read_b128 a[24:27], v12 offset:8192
ds_read_b128 a[28:31], v13 offset:8192
v_max3_f32 v43, v43, v131, v132
v_mfma_f32_32x32x16_bf16 v[144:159], a[48:51], a[120:123], v[144:159]
s_add_u32 s71, s71, 1024
buffer_load_dwordx4 v23, s[24:27], s71 offen offset:3072 lds
v_max3_f32 v43, v43, v133, v134
v_mfma_f32_32x32x16_bf16 v[144:159], a[52:55], a[124:127], v[144:159]
s_add_u32 m0, s57, 12288
s_xor_b32 s71, s75, 40960
buffer_load_dwordx4 v22, s[24:27], s71 offen lds
v_max3_f32 v43, v43, v135, v136
v_mfma_f32_32x32x16_bf16 v[144:159], a[56:59], a[128:131], v[144:159]
s_add_u32 s71, s71, 1024
buffer_load_dwordx4 v23, s[24:27], s71 offen offset:1024 lds
v_max3_f32 v43, v43, v137, v138
v_max3_f32 v43, v43, v139, v140
v_mfma_f32_32x32x16_bf16 v[144:159], a[60:63], a[132:135], v[144:159]
s_add_u32 s71, s71, 1024
buffer_load_dwordx4 v22, s[24:27], s71 offen offset:2048 lds
s_add_u32 s71, s71, 1024
buffer_load_dwordx4 v23, s[24:27], s71 offen offset:3072 lds
s_add_u32 m0, s57, 20480
s_xor_b32 s71, s75, 41088
buffer_load_dwordx4 v22, s[24:27], s71 offen lds
s_add_u32 s71, s71, 1024
buffer_load_dwordx4 v23, s[24:27], s71 offen offset:1024 lds
v_max3_f32 v43, v43, v141, v142
v_max_f32 v43, v43, v143
s_waitcnt lgkmcnt(0)
v_mfma_f32_32x32x16_bf16 v[160:175], a[0:3], v[64:67], 0
s_add_u32 s71, s71, 1024
buffer_load_dwordx4 v22, s[24:27], s71 offen offset:2048 lds
v_mfma_f32_32x32x16_bf16 v[160:175], a[4:7], v[68:71], v[160:175]
s_add_u32 s71, s71, 1024
buffer_load_dwordx4 v23, s[24:27], s71 offen offset:3072 lds
v_mfma_f32_32x32x16_bf16 v[160:175], a[8:11], a[112:115], v[160:175]
v_max3_f32 v43, v43, v144, v145
v_mfma_f32_32x32x16_bf16 v[160:175], a[12:15], a[116:119], v[160:175]
s_waitcnt vmcnt(16)
ds_read_b128 a[32:35], v10 offset:16384
ds_read_b128 a[36:39], v11 offset:16384
ds_read_b128 a[40:43], v12 offset:16384
ds_read_b128 a[44:47], v13 offset:16384
ds_read_b128 a[48:51], v10 offset:24576
ds_read_b128 a[52:55], v11 offset:24576
ds_read_b128 a[56:59], v12 offset:24576
ds_read_b128 a[60:63], v13 offset:24576
v_max3_f32 v43, v43, v146, v147
v_mfma_f32_32x32x16_bf16 v[160:175], a[16:19], a[120:123], v[160:175]
s_add_u32 m0, s57, 32768
s_xor_b32 s71, s75, 49152
buffer_load_dwordx4 v22, s[24:27], s71 offen lds
v_max3_f32 v43, v43, v148, v149
v_mfma_f32_32x32x16_bf16 v[160:175], a[20:23], a[124:127], v[160:175]
s_add_u32 s71, s71, 1024
buffer_load_dwordx4 v23, s[24:27], s71 offen offset:1024 lds
v_max3_f32 v43, v43, v150, v151
v_mfma_f32_32x32x16_bf16 v[160:175], a[24:27], a[128:131], v[160:175]
s_add_u32 s71, s71, 1024
buffer_load_dwordx4 v22, s[24:27], s71 offen offset:2048 lds
v_max3_f32 v43, v43, v152, v153
v_max3_f32 v43, v43, v154, v155
v_mfma_f32_32x32x16_bf16 v[160:175], a[28:31], a[132:135], v[160:175]
s_add_u32 s71, s71, 1024
buffer_load_dwordx4 v23, s[24:27], s71 offen offset:3072 lds
s_add_u32 m0, s57, 4096
s_xor_b32 s71, s75, 49280
buffer_load_dwordx4 v22, s[24:27], s71 offen lds
s_add_u32 s71, s71, 1024
buffer_load_dwordx4 v23, s[24:27], s71 offen offset:1024 lds
s_add_u32 s71, s71, 1024
buffer_load_dwordx4 v22, s[24:27], s71 offen offset:2048 lds
v_max3_f32 v43, v43, v156, v157
v_max3_f32 v43, v43, v158, v159
s_waitcnt lgkmcnt(0)
v_mfma_f32_32x32x16_bf16 v[176:191], a[32:35], v[64:67], 0
s_add_u32 s71, s71, 1024
buffer_load_dwordx4 v23, s[24:27], s71 offen offset:3072 lds
v_mfma_f32_32x32x16_bf16 v[176:191], a[36:39], v[68:71], v[176:191]
v_mfma_f32_32x32x16_bf16 v[176:191], a[40:43], a[112:115], v[176:191]
v_max3_f32 v43, v43, v160, v161
v_mfma_f32_32x32x16_bf16 v[176:191], a[44:47], a[116:119], v[176:191]
s_waitcnt vmcnt(16)
ds_read_b128 a[0:3], v10 offset:28672
ds_read_b128 a[4:7], v11 offset:28672
ds_read_b128 a[8:11], v12 offset:28672
ds_read_b128 a[12:15], v13 offset:28672
ds_read_b128 a[16:19], v10
ds_read_b128 a[20:23], v11
ds_read_b128 a[24:27], v12
ds_read_b128 a[28:31], v13
v_max3_f32 v43, v43, v162, v163
v_mfma_f32_32x32x16_bf16 v[176:191], a[48:51], a[120:123], v[176:191]
s_add_u32 m0, s57, 8192
s_xor_b32 s71, s75, 57344
buffer_load_dwordx4 v22, s[24:27], s71 offen lds
v_max3_f32 v43, v43, v164, v165
v_mfma_f32_32x32x16_bf16 v[176:191], a[52:55], a[124:127], v[176:191]
s_add_u32 s71, s71, 1024
buffer_load_dwordx4 v23, s[24:27], s71 offen offset:1024 lds
v_max3_f32 v43, v43, v166, v167
v_mfma_f32_32x32x16_bf16 v[176:191], a[56:59], a[128:131], v[176:191]
s_add_u32 s71, s71, 1024
buffer_load_dwordx4 v22, s[24:27], s71 offen offset:2048 lds
v_max3_f32 v43, v43, v168, v169
v_max3_f32 v43, v43, v170, v171
v_mfma_f32_32x32x16_bf16 v[176:191], a[60:63], a[132:135], v[176:191]
s_add_u32 s71, s71, 1024
buffer_load_dwordx4 v23, s[24:27], s71 offen offset:3072 lds
s_add_u32 m0, s57, 16384
s_xor_b32 s71, s75, 57472
buffer_load_dwordx4 v22, s[24:27], s71 offen lds
s_add_u32 s71, s71, 1024
buffer_load_dwordx4 v23, s[24:27], s71 offen offset:1024 lds
s_add_u32 s71, s71, 1024
buffer_load_dwordx4 v22, s[24:27], s71 offen offset:2048 lds
v_max3_f32 v43, v43, v172, v173
v_max3_f32 v43, v43, v174, v175
s_waitcnt lgkmcnt(0)
v_mfma_f32_32x32x16_bf16 v[192:207], a[0:3], v[64:67], 0
s_add_u32 s71, s71, 1024
buffer_load_dwordx4 v23, s[24:27], s71 offen offset:3072 lds
v_mfma_f32_32x32x16_bf16 v[192:207], a[4:7], v[68:71], v[192:207]
v_mfma_f32_32x32x16_bf16 v[192:207], a[8:11], a[112:115], v[192:207]
v_max3_f32 v43, v43, v176, v177
v_mfma_f32_32x32x16_bf16 v[192:207], a[12:15], a[116:119], v[192:207]
s_waitcnt vmcnt(16)
ds_read_b128 a[32:35], v10 offset:12288
ds_read_b128 a[36:39], v11 offset:12288
ds_read_b128 a[40:43], v12 offset:12288
ds_read_b128 a[44:47], v13 offset:12288
ds_read_b128 a[48:51], v10 offset:20480
ds_read_b128 a[52:55], v11 offset:20480
ds_read_b128 a[56:59], v12 offset:20480
ds_read_b128 a[60:63], v13 offset:20480
v_max3_f32 v43, v43, v178, v179
v_mfma_f32_32x32x16_bf16 v[192:207], a[16:19], a[120:123], v[192:207]
s_add_u32 m0, s57, 24576
s_xor_b32 s71, s63, 0
buffer_load_dwordx4 v26, s[28:31], s71 offen lds
v_max3_f32 v43, v43, v180, v181
v_mfma_f32_32x32x16_bf16 v[192:207], a[20:23], a[124:127], v[192:207]
buffer_load_dwordx4 v26, s[28:31], s71 offen offset:1024 lds
v_max3_f32 v43, v43, v182, v183
v_mfma_f32_32x32x16_bf16 v[192:207], a[24:27], a[128:131], v[192:207]
buffer_load_dwordx4 v26, s[28:31], s71 offen offset:2048 lds
v_max3_f32 v43, v43, v184, v185
v_max3_f32 v43, v43, v186, v187
v_mfma_f32_32x32x16_bf16 v[192:207], a[28:31], a[132:135], v[192:207]
buffer_load_dwordx4 v26, s[28:31], s71 offen offset:3072 lds
s_add_u32 m0, s57, 28672
s_xor_b32 s71, s63, 4096
buffer_load_dwordx4 v26, s[28:31], s71 offen lds
buffer_load_dwordx4 v26, s[28:31], s71 offen offset:1024 lds
buffer_load_dwordx4 v26, s[28:31], s71 offen offset:2048 lds
v_max3_f32 v43, v43, v188, v189
v_max3_f32 v43, v43, v190, v191
s_waitcnt lgkmcnt(0)
v_mfma_f32_32x32x16_bf16 v[208:223], a[32:35], v[64:67], 0
v_mfma_f32_32x32x16_bf16 v[208:223], a[36:39], v[68:71], v[208:223]
v_mfma_f32_32x32x16_bf16 v[208:223], a[40:43], a[112:115], v[208:223]
v_max3_f32 v43, v43, v192, v193
v_mfma_f32_32x32x16_bf16 v[208:223], a[44:47], a[116:119], v[208:223]
s_waitcnt vmcnt(15)
ds_read_b128 a[0:3], v10 offset:32768
ds_read_b128 a[4:7], v11 offset:32768
ds_read_b128 a[8:11], v12 offset:32768
ds_read_b128 a[12:15], v13 offset:32768
ds_read_b128 a[16:19], v10 offset:4096
ds_read_b128 a[20:23], v11 offset:4096
ds_read_b128 a[24:27], v12 offset:4096
ds_read_b128 a[28:31], v13 offset:4096
v_max3_f32 v43, v43, v194, v195
v_mfma_f32_32x32x16_bf16 v[208:223], a[48:51], a[120:123], v[208:223]
buffer_load_dwordx4 v26, s[28:31], s71 offen offset:3072 lds
v_max3_f32 v43, v43, v196, v197
v_mfma_f32_32x32x16_bf16 v[208:223], a[52:55], a[124:127], v[208:223]
s_add_u32 m0, s57, 0
s_xor_b32 s71, s63, 8192
buffer_load_dwordx4 v26, s[28:31], s71 offen lds
v_max3_f32 v43, v43, v198, v199
v_mfma_f32_32x32x16_bf16 v[208:223], a[56:59], a[128:131], v[208:223]
buffer_load_dwordx4 v26, s[28:31], s71 offen offset:1024 lds
v_max3_f32 v43, v43, v200, v201
v_max3_f32 v43, v43, v202, v203
v_mfma_f32_32x32x16_bf16 v[208:223], a[60:63], a[132:135], v[208:223]
buffer_load_dwordx4 v26, s[28:31], s71 offen offset:2048 lds
buffer_load_dwordx4 v26, s[28:31], s71 offen offset:3072 lds
v_max3_f32 v43, v43, v204, v205
v_max3_f32 v43, v43, v206, v207
s_waitcnt lgkmcnt(0)
v_mfma_f32_32x32x16_bf16 v[224:239], a[0:3], v[64:67], 0
v_mfma_f32_32x32x16_bf16 v[224:239], a[4:7], v[68:71], v[224:239]
v_mfma_f32_32x32x16_bf16 v[224:239], a[8:11], a[112:115], v[224:239]
s_nop 3
v_max3_f32 v43, v43, v208, v209
v_mfma_f32_32x32x16_bf16 v[224:239], a[12:15], a[116:119], v[224:239]
s_waitcnt vmcnt(12)
ds_read_b128 a[32:35], v10 offset:8192
ds_read_b128 a[36:39], v11 offset:8192
ds_read_b128 a[40:43], v12 offset:8192
ds_read_b128 a[44:47], v13 offset:8192
ds_read_b128 a[48:51], v10 offset:16384
ds_read_b128 a[52:55], v11 offset:16384
ds_read_b128 a[56:59], v12 offset:16384
ds_read_b128 a[60:63], v13 offset:16384
v_max3_f32 v43, v43, v210, v211
v_mfma_f32_32x32x16_bf16 v[224:239], a[16:19], a[120:123], v[224:239]
s_add_u32 m0, s57, 12288
s_xor_b32 s71, s63, 12288
buffer_load_dwordx4 v26, s[28:31], s71 offen lds
v_max3_f32 v43, v43, v212, v213
v_mfma_f32_32x32x16_bf16 v[224:239], a[20:23], a[124:127], v[224:239]
buffer_load_dwordx4 v26, s[28:31], s71 offen offset:1024 lds
v_max3_f32 v43, v43, v214, v215
v_mfma_f32_32x32x16_bf16 v[224:239], a[24:27], a[128:131], v[224:239]
buffer_load_dwordx4 v26, s[28:31], s71 offen offset:2048 lds
v_max3_f32 v43, v43, v216, v217
v_max3_f32 v43, v43, v218, v219
v_mfma_f32_32x32x16_bf16 v[224:239], a[28:31], a[132:135], v[224:239]
buffer_load_dwordx4 v26, s[28:31], s71 offen offset:3072 lds
v_max3_f32 v43, v43, v220, v221
v_max3_f32 v43, v43, v222, v223
s_waitcnt lgkmcnt(0)
v_mfma_f32_32x32x16_bf16 v[240:255], a[32:35], v[64:67], 0
v_mfma_f32_32x32x16_bf16 v[240:255], a[36:39], v[68:71], v[240:255]
v_mfma_f32_32x32x16_bf16 v[240:255], a[40:43], a[112:115], v[240:255]
s_nop 4
v_max3_f32 v43, v43, v224, v225
v_mfma_f32_32x32x16_bf16 v[240:255], a[44:47], a[116:119], v[240:255]
v_max3_f32 v43, v43, v226, v227
v_mfma_f32_32x32x16_bf16 v[240:255], a[48:51], a[120:123], v[240:255]
v_max3_f32 v43, v43, v228, v229
v_mfma_f32_32x32x16_bf16 v[240:255], a[52:55], a[124:127], v[240:255]
v_max3_f32 v43, v43, v230, v231
v_mfma_f32_32x32x16_bf16 v[240:255], a[56:59], a[128:131], v[240:255]
v_max3_f32 v43, v43, v232, v233
v_max3_f32 v43, v43, v234, v235
v_mfma_f32_32x32x16_bf16 v[240:255], a[60:63], a[132:135], v[240:255]
v_max3_f32 v43, v43, v236, v237
v_max3_f32 v43, v43, v238, v239
s_add_u32 m0, s57, 20480
s_xor_b32 s71, s63, 16384
buffer_load_dwordx4 v26, s[28:31], s71 offen lds
buffer_load_dwordx4 v26, s[28:31], s71 offen offset:1024 lds
buffer_load_dwordx4 v26, s[28:31], s71 offen offset:2048 lds
buffer_load_dwordx4 v26, s[28:31], s71 offen offset:3072 lds
v_and_b32 v37, 31, v0
v_lshlrev_b32 v37, 4, v37
s_lshl_b32 s58, s52, 2
v_add_u32 v38, s58, v37
v_max3_f32 v43, v43, v240, v241
v_max3_f32 v43, v43, v242, v243
v_max3_f32 v43, v43, v244, v245
v_max3_f32 v43, v43, v246, v247
v_max3_f32 v43, v43, v248, v249
v_max3_f32 v43, v43, v250, v251
v_max3_f32 v43, v43, v252, v253
v_max3_f32 v43, v43, v254, v255
v_mov_b32 v36, v43
s_nop 1
v_permlane32_swap_b32 v43, v36
v_max_f32 v43, v43, v36
ds_write_b32 v38, v43 offset:38912
s_waitcnt lgkmcnt(0)
s_barrier
ds_read_b128 v[44:47], v37 offset:38912
s_add_u32 m0, s57, 32768
s_xor_b32 s71, s63, 20480
buffer_load_dwordx4 v26, s[28:31], s71 offen lds
buffer_load_dwordx4 v26, s[28:31], s71 offen offset:1024 lds
buffer_load_dwordx4 v26, s[28:31], s71 offen offset:2048 lds
buffer_load_dwordx4 v26, s[28:31], s71 offen offset:3072 lds
s_waitcnt lgkmcnt(0)
v_max3_f32 v43, v44, v45, v46
v_max_f32 v43, v43, v47
v_mul_f32 v40, s69, v43
v_fma_f32 v128, v128, s69, -v40
v_fma_f32 v129, v129, s69, -v40
v_exp_f32 v128, v128
v_exp_f32 v129, v129
v_fma_f32 v130, v130, s69, -v40
v_fma_f32 v131, v131, s69, -v40
s_add_u32 m0, s57, 4096
s_xor_b32 s71, s63, 24576
buffer_load_dwordx4 v26, s[28:31], s71 offen lds
v_exp_f32 v130, v130
v_exp_f32 v131, v131
v_cvt_pk_bf16_f32 v128, v128, v129
v_fma_f32 v132, v132, s69, -v40
v_fma_f32 v133, v133, s69, -v40
v_exp_f32 v132, v132
buffer_load_dwordx4 v26, s[28:31], s71 offen offset:1024 lds
v_exp_f32 v133, v133
v_cvt_pk_bf16_f32 v129, v130, v131
v_fma_f32 v134, v134, s69, -v40
v_fma_f32 v135, v135, s69, -v40
v_exp_f32 v134, v134
v_exp_f32 v135, v135
buffer_load_dwordx4 v26, s[28:31], s71 offen offset:2048 lds
v_cvt_pk_bf16_f32 v130, v132, v133
v_fma_f32 v136, v136, s69, -v40
v_fma_f32 v137, v137, s69, -v40
v_exp_f32 v136, v136
v_exp_f32 v137, v137
v_cvt_pk_bf16_f32 v131, v134, v135
buffer_load_dwordx4 v26, s[28:31], s71 offen offset:3072 lds
s_waitcnt vmcnt(20)
ds_read_b64_tr_b16 a[0:1], v6 offset:24576
ds_read_b64_tr_b16 a[2:3], v6 offset:25600
ds_read_b64_tr_b16 a[4:5], v6 offset:28672
ds_read_b64_tr_b16 a[6:7], v6 offset:29696
ds_read_b64_tr_b16 a[8:9], v7 offset:24576
ds_read_b64_tr_b16 a[10:11], v7 offset:25600
ds_read_b64_tr_b16 a[12:13], v7 offset:28672
ds_read_b64_tr_b16 a[14:15], v7 offset:29696
ds_read_b64_tr_b16 a[16:17], v8 offset:24576
ds_read_b64_tr_b16 a[18:19], v8 offset:25600
ds_read_b64_tr_b16 a[20:21], v8 offset:28672
ds_read_b64_tr_b16 a[22:23], v8 offset:29696
ds_read_b64_tr_b16 a[24:25], v9 offset:24576
ds_read_b64_tr_b16 a[26:27], v9 offset:25600
ds_read_b64_tr_b16 a[28:29], v9 offset:28672
ds_read_b64_tr_b16 a[30:31], v9 offset:29696
v_fma_f32 v138, v138, s69, -v40
v_fma_f32 v139, v139, s69, -v40
v_exp_f32 v138, v138
v_exp_f32 v139, v139
v_cvt_pk_bf16_f32 v132, v136, v137
v_fma_f32 v140, v140, s69, -v40
s_add_u32 m0, s57, 8192
s_xor_b32 s71, s63, 28672
buffer_load_dwordx4 v26, s[28:31], s71 offen lds
v_fma_f32 v141, v141, s69, -v40
v_exp_f32 v140, v140
v_exp_f32 v141, v141
v_cvt_pk_bf16_f32 v133, v138, v139
v_fma_f32 v142, v142, s69, -v40
v_fma_f32 v143, v143, s69, -v40
buffer_load_dwordx4 v26, s[28:31], s71 offen offset:1024 lds
v_exp_f32 v142, v142
v_exp_f32 v143, v143
v_cvt_pk_bf16_f32 v134, v140, v141
v_cvt_pk_bf16_f32 v135, v142, v143
s_waitcnt lgkmcnt(0)
v_mfma_f32_32x32x16_bf16 a[112:127], v[124:127], v[128:131], 0
buffer_load_dwordx4 v26, s[28:31], s71 offen offset:2048 lds
v_fma_f32 v144, v144, s69, -v40
v_fma_f32 v145, v145, s69, -v40
v_exp_f32 v144, v144
v_exp_f32 v145, v145
v_mfma_f32_32x32x16_bf16 a[64:79], a[8:11], v[128:131], 0
buffer_load_dwordx4 v26, s[28:31], s71 offen offset:3072 lds
v_fma_f32 v146, v146, s69, -v40
v_fma_f32 v147, v147, s69, -v40
v_exp_f32 v146, v146
v_exp_f32 v147, v147
v_mfma_f32_32x32x16_bf16 a[80:95], a[16:19], v[128:131], 0
s_add_u32 m0, s57, 16384
s_xor_b32 s71, s63, 32768
buffer_load_dwordx4 v26, s[28:31], s71 offen lds
v_cvt_pk_bf16_f32 v144, v144, v145
v_fma_f32 v148, v148, s69, -v40
v_fma_f32 v149, v149, s69, -v40
v_exp_f32 v148, v148
v_mfma_f32_32x32x16_bf16 a[96:111], a[24:27], v[128:131], 0
buffer_load_dwordx4 v26, s[28:31], s71 offen offset:1024 lds
v_exp_f32 v149, v149
v_cvt_pk_bf16_f32 v145, v146, v147
v_fma_f32 v150, v150, s69, -v40
v_fma_f32 v151, v151, s69, -v40
v_mfma_f32_32x32x16_bf16 v[48:63], a[0:3], v[128:131], 0
buffer_load_dwordx4 v26, s[28:31], s71 offen offset:2048 lds
s_waitcnt vmcnt(19)
ds_read_b64_tr_b16 a[32:33], v6
ds_read_b64_tr_b16 a[34:35], v6 offset:1024
ds_read_b64_tr_b16 a[36:37], v6 offset:12288
ds_read_b64_tr_b16 a[38:39], v6 offset:13312
v_exp_f32 v150, v150
v_exp_f32 v151, v151
v_cvt_pk_bf16_f32 v146, v148, v149
v_fma_f32 v152, v152, s69, -v40
v_mfma_f32_32x32x16_bf16 a[112:127], v[124:127], v[132:135], a[112:127]
buffer_load_dwordx4 v26, s[28:31], s71 offen offset:3072 lds
ds_read_b64_tr_b16 a[40:41], v7
ds_read_b64_tr_b16 a[42:43], v7 offset:1024
ds_read_b64_tr_b16 a[44:45], v7 offset:12288
ds_read_b64_tr_b16 a[46:47], v7 offset:13312
v_fma_f32 v153, v153, s69, -v40
v_exp_f32 v152, v152
v_exp_f32 v153, v153
v_cvt_pk_bf16_f32 v147, v150, v151
v_mfma_f32_32x32x16_bf16 a[64:79], a[12:15], v[132:135], a[64:79]
s_add_u32 m0, s57, 24576
s_xor_b32 s71, s63, 36864
buffer_load_dwordx4 v26, s[28:31], s71 offen lds
ds_read_b64_tr_b16 a[48:49], v8
ds_read_b64_tr_b16 a[50:51], v8 offset:1024
ds_read_b64_tr_b16 a[52:53], v8 offset:12288
ds_read_b64_tr_b16 a[54:55], v8 offset:13312
v_fma_f32 v154, v154, s69, -v40
v_fma_f32 v155, v155, s69, -v40
v_exp_f32 v154, v154
v_exp_f32 v155, v155
v_mfma_f32_32x32x16_bf16 a[80:95], a[20:23], v[132:135], a[80:95]
buffer_load_dwordx4 v26, s[28:31], s71 offen offset:1024 lds
buffer_load_dwordx4 v26, s[28:31], s71 offen offset:2048 lds
buffer_load_dwordx4 v26, s[28:31], s71 offen offset:3072 lds
s_add_u32 m0, s57, 28672
s_xor_b32 s71, s63, 40960
buffer_load_dwordx4 v26, s[28:31], s71 offen lds
ds_read_b64_tr_b16 a[56:57], v9
ds_read_b64_tr_b16 a[58:59], v9 offset:1024
ds_read_b64_tr_b16 a[60:61], v9 offset:12288
ds_read_b64_tr_b16 a[62:63], v9 offset:13312
v_cvt_pk_bf16_f32 v148, v152, v153
v_fma_f32 v156, v156, s69, -v40
v_fma_f32 v157, v157, s69, -v40
v_exp_f32 v156, v156
v_mfma_f32_32x32x16_bf16 a[96:111], a[28:31], v[132:135], a[96:111]
v_exp_f32 v157, v157
v_cvt_pk_bf16_f32 v149, v154, v155
v_fma_f32 v158, v158, s69, -v40
v_fma_f32 v159, v159, s69, -v40
v_mfma_f32_32x32x16_bf16 v[48:63], a[4:7], v[132:135], v[48:63]
v_exp_f32 v158, v158
v_exp_f32 v159, v159
v_cvt_pk_bf16_f32 v150, v156, v157
v_cvt_pk_bf16_f32 v151, v158, v159
s_waitcnt lgkmcnt(0)
v_mfma_f32_32x32x16_bf16 a[112:127], v[124:127], v[144:147], a[112:127]
buffer_load_dwordx4 v26, s[28:31], s71 offen offset:1024 lds
v_fma_f32 v160, v160, s69, -v40
v_fma_f32 v161, v161, s69, -v40
v_exp_f32 v160, v160
v_exp_f32 v161, v161
v_mfma_f32_32x32x16_bf16 a[64:79], a[40:43], v[144:147], a[64:79]
buffer_load_dwordx4 v26, s[28:31], s71 offen offset:2048 lds
v_fma_f32 v162, v162, s69, -v40
v_fma_f32 v163, v163, s69, -v40
v_exp_f32 v162, v162
v_exp_f32 v163, v163
v_mfma_f32_32x32x16_bf16 a[80:95], a[48:51], v[144:147], a[80:95]
buffer_load_dwordx4 v26, s[28:31], s71 offen offset:3072 lds
v_cvt_pk_bf16_f32 v160, v160, v161
v_fma_f32 v164, v164, s69, -v40
v_fma_f32 v165, v165, s69, -v40
v_exp_f32 v164, v164
v_mfma_f32_32x32x16_bf16 a[96:111], a[56:59], v[144:147], a[96:111]
s_add_u32 m0, s57, 0
s_xor_b32 s71, s63, 45056
buffer_load_dwordx4 v26, s[28:31], s71 offen lds
v_exp_f32 v165, v165
v_cvt_pk_bf16_f32 v161, v162, v163
v_fma_f32 v166, v166, s69, -v40
v_fma_f32 v167, v167, s69, -v40
v_mfma_f32_32x32x16_bf16 v[48:63], a[32:35], v[144:147], v[48:63]
buffer_load_dwordx4 v26, s[28:31], s71 offen offset:1024 lds
s_waitcnt vmcnt(22)
ds_read_b64_tr_b16 a[0:1], v6 offset:20480
ds_read_b64_tr_b16 a[2:3], v6 offset:21504
ds_read_b64_tr_b16 a[4:5], v6 offset:32768
ds_read_b64_tr_b16 a[6:7], v6 offset:33792
v_exp_f32 v166, v166
v_exp_f32 v167, v167
v_cvt_pk_bf16_f32 v162, v164, v165
v_fma_f32 v168, v168, s69, -v40
v_mfma_f32_32x32x16_bf16 a[112:127], v[124:127], v[148:151], a[112:127]
buffer_load_dwordx4 v26, s[28:31], s71 offen offset:2048 lds
ds_read_b64_tr_b16 a[8:9], v7 offset:20480
ds_read_b64_tr_b16 a[10:11], v7 offset:21504
ds_read_b64_tr_b16 a[12:13], v7 offset:32768
ds_read_b64_tr_b16 a[14:15], v7 offset:33792
v_fma_f32 v169, v169, s69, -v40
v_exp_f32 v168, v168
v_exp_f32 v169, v169
v_cvt_pk_bf16_f32 v163, v166, v167
v_mfma_f32_32x32x16_bf16 a[64:79], a[44:47], v[148:151], a[64:79]
buffer_load_dwordx4 v26, s[28:31], s71 offen offset:3072 lds
ds_read_b64_tr_b16 a[16:17], v8 offset:20480
ds_read_b64_tr_b16 a[18:19], v8 offset:21504
ds_read_b64_tr_b16 a[20:21], v8 offset:32768
ds_read_b64_tr_b16 a[22:23], v8 offset:33792
v_fma_f32 v170, v170, s69, -v40
v_fma_f32 v171, v171, s69, -v40
v_exp_f32 v170, v170
v_exp_f32 v171, v171
v_mfma_f32_32x32x16_bf16 a[80:95], a[52:55], v[148:151], a[80:95]
s_add_u32 m0, s57, 12288
s_xor_b32 s71, s63, 49152
buffer_load_dwordx4 v26, s[28:31], s71 offen lds
buffer_load_dwordx4 v26, s[28:31], s71 offen offset:1024 lds
buffer_load_dwordx4 v26, s[28:31], s71 offen offset:2048 lds
buffer_load_dwordx4 v26, s[28:31], s71 offen offset:3072 lds
ds_read_b64_tr_b16 a[24:25], v9 offset:20480
ds_read_b64_tr_b16 a[26:27], v9 offset:21504
ds_read_b64_tr_b16 a[28:29], v9 offset:32768
ds_read_b64_tr_b16 a[30:31], v9 offset:33792
v_cvt_pk_bf16_f32 v164, v168, v169
v_fma_f32 v172, v172, s69, -v40
v_fma_f32 v173, v173, s69, -v40
v_exp_f32 v172, v172
v_mfma_f32_32x32x16_bf16 a[96:111], a[60:63], v[148:151], a[96:111]
v_exp_f32 v173, v173
v_cvt_pk_bf16_f32 v165, v170, v171
v_fma_f32 v174, v174, s69, -v40
v_fma_f32 v175, v175, s69, -v40
v_mfma_f32_32x32x16_bf16 v[48:63], a[36:39], v[148:151], v[48:63]
v_exp_f32 v174, v174
v_exp_f32 v175, v175
v_cvt_pk_bf16_f32 v166, v172, v173
v_cvt_pk_bf16_f32 v167, v174, v175
s_waitcnt lgkmcnt(0)
s_lshl_b32 s58, s53, 5
v_lshl_add_u32 v36, v0, 3, s58
s_lshl_b32 s58, s14, 5
s_lshl_b32 s59, s55, 3
s_add_u32 s58, s58, s59
v_writelane_b32 v36, s58, 4
s_add_u32 s58, s58, 32
v_writelane_b32 v36, s58, 5
s_mov_b64 exec, 63
buffer_load_dword v39, v36, s[44:47], 0 offen sc1
s_mov_b64 exec, -1
v_mfma_f32_32x32x16_bf16 a[112:127], v[124:127], v[160:163], a[112:127]
s_add_u32 m0, s57, 20480
s_xor_b32 s71, s63, 53248
buffer_load_dwordx4 v26, s[28:31], s71 offen lds
v_fma_f32 v176, v176, s69, -v40
v_fma_f32 v177, v177, s69, -v40
v_exp_f32 v176, v176
v_exp_f32 v177, v177
v_mfma_f32_32x32x16_bf16 a[64:79], a[8:11], v[160:163], a[64:79]
buffer_load_dwordx4 v26, s[28:31], s71 offen offset:1024 lds
v_fma_f32 v178, v178, s69, -v40
v_fma_f32 v179, v179, s69, -v40
v_exp_f32 v178, v178
v_exp_f32 v179, v179
v_mfma_f32_32x32x16_bf16 a[80:95], a[16:19], v[160:163], a[80:95]
buffer_load_dwordx4 v26, s[28:31], s71 offen offset:2048 lds
v_cvt_pk_bf16_f32 v176, v176, v177
v_fma_f32 v180, v180, s69, -v40
v_fma_f32 v181, v181, s69, -v40
v_exp_f32 v180, v180
v_mfma_f32_32x32x16_bf16 a[96:111], a[24:27], v[160:163], a[96:111]
v_exp_f32 v181, v181
v_cvt_pk_bf16_f32 v177, v178, v179
v_fma_f32 v182, v182, s69, -v40
v_fma_f32 v183, v183, s69, -v40
v_mfma_f32_32x32x16_bf16 v[48:63], a[0:3], v[160:163], v[48:63]
s_waitcnt vmcnt(24)
ds_read_b64_tr_b16 a[32:33], v6 offset:4096
ds_read_b64_tr_b16 a[34:35], v6 offset:5120
ds_read_b64_tr_b16 a[36:37], v6 offset:8192
ds_read_b64_tr_b16 a[38:39], v6 offset:9216
v_exp_f32 v182, v182
v_exp_f32 v183, v183
v_cvt_pk_bf16_f32 v178, v180, v181
v_fma_f32 v184, v184, s69, -v40
v_mfma_f32_32x32x16_bf16 a[112:127], v[124:127], v[164:167], a[112:127]
buffer_load_dwordx4 v26, s[28:31], s71 offen offset:3072 lds
ds_read_b64_tr_b16 a[40:41], v7 offset:4096
ds_read_b64_tr_b16 a[42:43], v7 offset:5120
ds_read_b64_tr_b16 a[44:45], v7 offset:8192
ds_read_b64_tr_b16 a[46:47], v7 offset:9216
v_fma_f32 v185, v185, s69, -v40
v_exp_f32 v184, v184
v_exp_f32 v185, v185
v_cvt_pk_bf16_f32 v179, v182, v183
v_mfma_f32_32x32x16_bf16 a[64:79], a[12:15], v[164:167], a[64:79]
s_add_u32 m0, s57, 32768
s_xor_b32 s71, s63, 57344
buffer_load_dwordx4 v26, s[28:31], s71 offen lds
ds_read_b64_tr_b16 a[48:49], v8 offset:4096
ds_read_b64_tr_b16 a[50:51], v8 offset:5120
ds_read_b64_tr_b16 a[52:53], v8 offset:8192
ds_read_b64_tr_b16 a[54:55], v8 offset:9216
v_fma_f32 v186, v186, s69, -v40
v_fma_f32 v187, v187, s69, -v40
v_exp_f32 v186, v186
v_exp_f32 v187, v187
v_mfma_f32_32x32x16_bf16 a[80:95], a[20:23], v[164:167], a[80:95]
buffer_load_dwordx4 v26, s[28:31], s71 offen offset:1024 lds
buffer_load_dwordx4 v26, s[28:31], s71 offen offset:2048 lds
buffer_load_dwordx4 v26, s[28:31], s71 offen offset:3072 lds
ds_read_b64_tr_b16 a[56:57], v9 offset:4096
ds_read_b64_tr_b16 a[58:59], v9 offset:5120
ds_read_b64_tr_b16 a[60:61], v9 offset:8192
ds_read_b64_tr_b16 a[62:63], v9 offset:9216
v_cvt_pk_bf16_f32 v180, v184, v185
v_fma_f32 v188, v188, s69, -v40
v_fma_f32 v189, v189, s69, -v40
v_exp_f32 v188, v188
v_mfma_f32_32x32x16_bf16 a[96:111], a[28:31], v[164:167], a[96:111]
v_exp_f32 v189, v189
v_cvt_pk_bf16_f32 v181, v186, v187
v_fma_f32 v190, v190, s69, -v40
v_fma_f32 v191, v191, s69, -v40
v_mfma_f32_32x32x16_bf16 v[48:63], a[4:7], v[164:167], v[48:63]
v_exp_f32 v190, v190
v_exp_f32 v191, v191
v_cvt_pk_bf16_f32 v182, v188, v189
v_cvt_pk_bf16_f32 v183, v190, v191
s_waitcnt lgkmcnt(0)
v_mfma_f32_32x32x16_bf16 a[112:127], v[124:127], v[176:179], a[112:127]
s_add_u32 m0, s57, 4096
s_xor_b32 s71, s63, 61440
buffer_load_dwordx4 v26, s[28:31], s71 offen lds
v_fma_f32 v192, v192, s69, -v40
v_fma_f32 v193, v193, s69, -v40
v_exp_f32 v192, v192
v_exp_f32 v193, v193
v_mfma_f32_32x32x16_bf16 a[64:79], a[40:43], v[176:179], a[64:79]
buffer_load_dwordx4 v26, s[28:31], s71 offen offset:1024 lds
v_fma_f32 v194, v194, s69, -v40
v_fma_f32 v195, v195, s69, -v40
v_exp_f32 v194, v194
v_exp_f32 v195, v195
v_mfma_f32_32x32x16_bf16 a[80:95], a[48:51], v[176:179], a[80:95]
buffer_load_dwordx4 v26, s[28:31], s71 offen offset:2048 lds
v_cvt_pk_bf16_f32 v192, v192, v193
v_fma_f32 v196, v196, s69, -v40
v_fma_f32 v197, v197, s69, -v40
v_exp_f32 v196, v196
v_mfma_f32_32x32x16_bf16 a[96:111], a[56:59], v[176:179], a[96:111]
v_exp_f32 v197, v197
v_cvt_pk_bf16_f32 v193, v194, v195
v_fma_f32 v198, v198, s69, -v40
v_fma_f32 v199, v199, s69, -v40
v_mfma_f32_32x32x16_bf16 v[48:63], a[32:35], v[176:179], v[48:63]
s_waitcnt vmcnt(24)
ds_read_b64_tr_b16 a[0:1], v6 offset:16384
ds_read_b64_tr_b16 a[2:3], v6 offset:17408
ds_read_b64_tr_b16 a[4:5], v6 offset:24576
ds_read_b64_tr_b16 a[6:7], v6 offset:25600
v_exp_f32 v198, v198
v_exp_f32 v199, v199
v_cvt_pk_bf16_f32 v194, v196, v197
v_fma_f32 v200, v200, s69, -v40
v_mfma_f32_32x32x16_bf16 a[112:127], v[124:127], v[180:183], a[112:127]
buffer_load_dwordx4 v26, s[28:31], s71 offen offset:3072 lds
ds_read_b64_tr_b16 a[8:9], v7 offset:16384
ds_read_b64_tr_b16 a[10:11], v7 offset:17408
ds_read_b64_tr_b16 a[12:13], v7 offset:24576
ds_read_b64_tr_b16 a[14:15], v7 offset:25600
v_fma_f32 v201, v201, s69, -v40
v_exp_f32 v200, v200
v_exp_f32 v201, v201
v_cvt_pk_bf16_f32 v195, v198, v199
v_mfma_f32_32x32x16_bf16 a[64:79], a[44:47], v[180:183], a[64:79]
ds_read_b64_tr_b16 a[16:17], v8 offset:16384
ds_read_b64_tr_b16 a[18:19], v8 offset:17408
ds_read_b64_tr_b16 a[20:21], v8 offset:24576
ds_read_b64_tr_b16 a[22:23], v8 offset:25600
v_fma_f32 v202, v202, s69, -v40
v_fma_f32 v203, v203, s69, -v40
v_exp_f32 v202, v202
v_exp_f32 v203, v203
v_mfma_f32_32x32x16_bf16 a[80:95], a[52:55], v[180:183], a[80:95]
s_add_u32 m0, s57, 8192
s_xor_b32 s71, s67, 0
buffer_load_dwordx4 v27, s[36:39], s71 offen lds
ds_read_b64_tr_b16 a[24:25], v9 offset:16384
ds_read_b64_tr_b16 a[26:27], v9 offset:17408
ds_read_b64_tr_b16 a[28:29], v9 offset:24576
ds_read_b64_tr_b16 a[30:31], v9 offset:25600
v_cvt_pk_bf16_f32 v196, v200, v201
v_fma_f32 v204, v204, s69, -v40
v_fma_f32 v205, v205, s69, -v40
v_exp_f32 v204, v204
v_mfma_f32_32x32x16_bf16 a[96:111], a[60:63], v[180:183], a[96:111]
v_exp_f32 v205, v205
v_cvt_pk_bf16_f32 v197, v202, v203
v_fma_f32 v206, v206, s69, -v40
v_fma_f32 v207, v207, s69, -v40
v_mfma_f32_32x32x16_bf16 v[48:63], a[36:39], v[180:183], v[48:63]
v_exp_f32 v206, v206
v_exp_f32 v207, v207
v_cvt_pk_bf16_f32 v198, v204, v205
v_cvt_pk_bf16_f32 v199, v206, v207
s_waitcnt vmcnt(13)
s_mov_b32 s72, 400000
s_mov_b64 exec, 63
L_ep:
v_cmp_ne_u32 vcc, 1, v39
s_cbranch_vccz L_epok
s_sub_u32 s72, s72, 1
s_cmp_eq_u32 s72, 0
s_cbranch_scc1 L_epok
s_sleep 16
buffer_load_dword v39, v36, s[44:47], 0 offen sc1
s_waitcnt vmcnt(0)
s_branch L_ep
L_epok:
s_mov_b64 exec, -1
s_waitcnt lgkmcnt(0)
v_mfma_f32_32x32x16_bf16 a[112:127], v[124:127], v[192:195], a[112:127]
v_fma_f32 v208, v208, s69, -v40
v_fma_f32 v209, v209, s69, -v40
v_exp_f32 v208, v208
v_exp_f32 v209, v209
v_mfma_f32_32x32x16_bf16 a[64:79], a[8:11], v[192:195], a[64:79]
s_add_u32 s71, s71, 15360
buffer_load_dwordx4 v27, s[36:39], s71 offen offset:1024 lds
v_fma_f32 v210, v210, s69, -v40
v_fma_f32 v211, v211, s69, -v40
v_exp_f32 v210, v210
v_exp_f32 v211, v211
v_mfma_f32_32x32x16_bf16 a[80:95], a[16:19], v[192:195], a[80:95]
v_cvt_pk_bf16_f32 v208, v208, v209
v_fma_f32 v212, v212, s69, -v40
v_fma_f32 v213, v213, s69, -v40
v_exp_f32 v212, v212
v_mfma_f32_32x32x16_bf16 a[96:111], a[24:27], v[192:195], a[96:111]
v_exp_f32 v213, v213
v_cvt_pk_bf16_f32 v209, v210, v211
v_fma_f32 v214, v214, s69, -v40
v_fma_f32 v215, v215, s69, -v40
v_mfma_f32_32x32x16_bf16 v[48:63], a[0:3], v[192:195], v[48:63]
s_add_u32 s71, s71, 15360
buffer_load_dwordx4 v27, s[36:39], s71 offen offset:2048 lds
ds_read_b64_tr_b16 a[32:33], v6 offset:28672
ds_read_b64_tr_b16 a[34:35], v6 offset:29696
ds_read_b64_tr_b16 a[36:37], v6
ds_read_b64_tr_b16 a[38:39], v6 offset:1024
v_exp_f32 v214, v214
v_exp_f32 v215, v215
v_cvt_pk_bf16_f32 v210, v212, v213
v_fma_f32 v216, v216, s69, -v40
v_mfma_f32_32x32x16_bf16 a[112:127], v[124:127], v[196:199], a[112:127]
ds_read_b64_tr_b16 a[40:41], v7 offset:28672
ds_read_b64_tr_b16 a[42:43], v7 offset:29696
ds_read_b64_tr_b16 a[44:45], v7
ds_read_b64_tr_b16 a[46:47], v7 offset:1024
v_fma_f32 v217, v217, s69, -v40
v_exp_f32 v216, v216
v_exp_f32 v217, v217
v_cvt_pk_bf16_f32 v211, v214, v215
v_mfma_f32_32x32x16_bf16 a[64:79], a[12:15], v[196:199], a[64:79]
ds_read_b64_tr_b16 a[48:49], v8 offset:28672
ds_read_b64_tr_b16 a[50:51], v8 offset:29696
ds_read_b64_tr_b16 a[52:53], v8
ds_read_b64_tr_b16 a[54:55], v8 offset:1024
v_fma_f32 v218, v218, s69, -v40
v_fma_f32 v219, v219, s69, -v40
v_exp_f32 v218, v218
v_exp_f32 v219, v219
v_mfma_f32_32x32x16_bf16 a[80:95], a[20:23], v[196:199], a[80:95]
s_add_u32 s71, s71, 15360
buffer_load_dwordx4 v27, s[36:39], s71 offen offset:3072 lds
ds_read_b64_tr_b16 a[56:57], v9 offset:28672
ds_read_b64_tr_b16 a[58:59], v9 offset:29696
ds_read_b64_tr_b16 a[60:61], v9
ds_read_b64_tr_b16 a[62:63], v9 offset:1024
v_cvt_pk_bf16_f32 v212, v216, v217
v_fma_f32 v220, v220, s69, -v40
v_fma_f32 v221, v221, s69, -v40
v_exp_f32 v220, v220
v_mfma_f32_32x32x16_bf16 a[96:111], a[28:31], v[196:199], a[96:111]
v_exp_f32 v221, v221
v_cvt_pk_bf16_f32 v213, v218, v219
v_fma_f32 v222, v222, s69, -v40
v_fma_f32 v223, v223, s69, -v40
v_mfma_f32_32x32x16_bf16 v[48:63], a[4:7], v[196:199], v[48:63]
v_exp_f32 v222, v222
v_exp_f32 v223, v223
v_cvt_pk_bf16_f32 v214, v220, v221
v_cvt_pk_bf16_f32 v215, v222, v223
s_waitcnt lgkmcnt(0)
v_mfma_f32_32x32x16_bf16 a[112:127], v[124:127], v[208:211], a[112:127]
v_fma_f32 v224, v224, s69, -v40
v_fma_f32 v225, v225, s69, -v40
v_exp_f32 v224, v224
v_exp_f32 v225, v225
v_mfma_f32_32x32x16_bf16 a[64:79], a[40:43], v[208:211], a[64:79]
s_add_u32 m0, s57, 16384
s_xor_b32 s71, s67, 65536
buffer_load_dwordx4 v27, s[36:39], s71 offen lds
v_fma_f32 v226, v226, s69, -v40
v_fma_f32 v227, v227, s69, -v40
v_exp_f32 v226, v226
v_exp_f32 v227, v227
v_mfma_f32_32x32x16_bf16 a[80:95], a[48:51], v[208:211], a[80:95]
v_cvt_pk_bf16_f32 v224, v224, v225
v_fma_f32 v228, v228, s69, -v40
v_fma_f32 v229, v229, s69, -v40
v_exp_f32 v228, v228
v_mfma_f32_32x32x16_bf16 a[96:111], a[56:59], v[208:211], a[96:111]
v_exp_f32 v229, v229
v_cvt_pk_bf16_f32 v225, v226, v227
v_fma_f32 v230, v230, s69, -v40
v_fma_f32 v231, v231, s69, -v40
v_mfma_f32_32x32x16_bf16 v[48:63], a[32:35], v[208:211], v[48:63]
s_add_u32 s71, s71, 15360
buffer_load_dwordx4 v27, s[36:39], s71 offen offset:1024 lds
s_waitcnt vmcnt(14)
ds_read_b64_tr_b16 a[0:1], v6 offset:12288
ds_read_b64_tr_b16 a[2:3], v6 offset:13312
ds_read_b64_tr_b16 a[4:5], v6 offset:20480
ds_read_b64_tr_b16 a[6:7], v6 offset:21504
v_exp_f32 v230, v230
v_exp_f32 v231, v231
v_cvt_pk_bf16_f32 v226, v228, v229
v_fma_f32 v232, v232, s69, -v40
v_mfma_f32_32x32x16_bf16 a[112:127], v[124:127], v[212:215], a[112:127]
ds_read_b64_tr_b16 a[8:9], v7 offset:12288
ds_read_b64_tr_b16 a[10:11], v7 offset:13312
ds_read_b64_tr_b16 a[12:13], v7 offset:20480
ds_read_b64_tr_b16 a[14:15], v7 offset:21504
v_fma_f32 v233, v233, s69, -v40
v_exp_f32 v232, v232
v_exp_f32 v233, v233
v_cvt_pk_bf16_f32 v227, v230, v231
v_mfma_f32_32x32x16_bf16 a[64:79], a[44:47], v[212:215], a[64:79]
ds_read_b64_tr_b16 a[16:17], v8 offset:12288
ds_read_b64_tr_b16 a[18:19], v8 offset:13312
ds_read_b64_tr_b16 a[20:21], v8 offset:20480
ds_read_b64_tr_b16 a[22:23], v8 offset:21504
v_fma_f32 v234, v234, s69, -v40
v_fma_f32 v235, v235, s69, -v40
v_exp_f32 v234, v234
v_exp_f32 v235, v235
v_mfma_f32_32x32x16_bf16 a[80:95], a[52:55], v[212:215], a[80:95]
s_add_u32 s71, s71, 15360
buffer_load_dwordx4 v27, s[36:39], s71 offen offset:2048 lds
ds_read_b64_tr_b16 a[24:25], v9 offset:12288
ds_read_b64_tr_b16 a[26:27], v9 offset:13312
ds_read_b64_tr_b16 a[28:29], v9 offset:20480
ds_read_b64_tr_b16 a[30:31], v9 offset:21504
v_cvt_pk_bf16_f32 v228, v232, v233
v_fma_f32 v236, v236, s69, -v40
v_fma_f32 v237, v237, s69, -v40
v_exp_f32 v236, v236
v_mfma_f32_32x32x16_bf16 a[96:111], a[60:63], v[212:215], a[96:111]
v_exp_f32 v237, v237
v_cvt_pk_bf16_f32 v229, v234, v235
v_fma_f32 v238, v238, s69, -v40
v_fma_f32 v239, v239, s69, -v40
v_mfma_f32_32x32x16_bf16 v[48:63], a[36:39], v[212:215], v[48:63]
v_exp_f32 v238, v238
v_exp_f32 v239, v239
v_cvt_pk_bf16_f32 v230, v236, v237
v_cvt_pk_bf16_f32 v231, v238, v239
s_waitcnt lgkmcnt(0)
v_mfma_f32_32x32x16_bf16 a[112:127], v[124:127], v[224:227], a[112:127]
v_fma_f32 v240, v240, s69, -v40
v_fma_f32 v241, v241, s69, -v40
v_exp_f32 v240, v240
v_exp_f32 v241, v241
v_mfma_f32_32x32x16_bf16 a[64:79], a[8:11], v[224:227], a[64:79]
s_add_u32 s71, s71, 15360
buffer_load_dwordx4 v27, s[36:39], s71 offen offset:3072 lds
v_fma_f32 v242, v242, s69, -v40
v_fma_f32 v243, v243, s69, -v40
v_exp_f32 v242, v242
v_exp_f32 v243, v243
v_mfma_f32_32x32x16_bf16 a[80:95], a[16:19], v[224:227], a[80:95]
v_cvt_pk_bf16_f32 v240, v240, v241
v_fma_f32 v244, v244, s69, -v40
v_fma_f32 v245, v245, s69, -v40
v_exp_f32 v244, v244
v_mfma_f32_32x32x16_bf16 a[96:111], a[24:27], v[224:227], a[96:111]
v_exp_f32 v245, v245
v_cvt_pk_bf16_f32 v241, v242, v243
v_fma_f32 v246, v246, s69, -v40
v_fma_f32 v247, v247, s69, -v40
v_mfma_f32_32x32x16_bf16 v[48:63], a[0:3], v[224:227], v[48:63]
s_add_u32 m0, s57, 24576
s_xor_b32 s71, s67, 131072
buffer_load_dwordx4 v27, s[36:39], s71 offen lds
s_waitcnt vmcnt(9)
ds_read_b64_tr_b16 a[32:33], v6 offset:32768
ds_read_b64_tr_b16 a[34:35], v6 offset:33792
ds_read_b64_tr_b16 a[36:37], v6 offset:4096
ds_read_b64_tr_b16 a[38:39], v6 offset:5120
v_exp_f32 v246, v246
v_exp_f32 v247, v247
v_cvt_pk_bf16_f32 v242, v244, v245
v_fma_f32 v248, v248, s69, -v40
v_mfma_f32_32x32x16_bf16 a[112:127], v[124:127], v[228:231], a[112:127]
ds_read_b64_tr_b16 a[40:41], v7 offset:32768
ds_read_b64_tr_b16 a[42:43], v7 offset:33792
ds_read_b64_tr_b16 a[44:45], v7 offset:4096
ds_read_b64_tr_b16 a[46:47], v7 offset:5120
v_fma_f32 v249, v249, s69, -v40
v_exp_f32 v248, v248
v_exp_f32 v249, v249
v_cvt_pk_bf16_f32 v243, v246, v247
v_mfma_f32_32x32x16_bf16 a[64:79], a[12:15], v[228:231], a[64:79]
ds_read_b64_tr_b16 a[48:49], v8 offset:32768
ds_read_b64_tr_b16 a[50:51], v8 offset:33792
ds_read_b64_tr_b16 a[52:53], v8 offset:4096
ds_read_b64_tr_b16 a[54:55], v8 offset:5120
v_fma_f32 v250, v250, s69, -v40
v_fma_f32 v251, v251, s69, -v40
v_exp_f32 v250, v250
v_exp_f32 v251, v251
v_mfma_f32_32x32x16_bf16 a[80:95], a[20:23], v[228:231], a[80:95]
s_add_u32 s71, s71, 15360
buffer_load_dwordx4 v27, s[36:39], s71 offen offset:1024 lds
ds_read_b64_tr_b16 a[56:57], v9 offset:32768
ds_read_b64_tr_b16 a[58:59], v9 offset:33792
ds_read_b64_tr_b16 a[60:61], v9 offset:4096
ds_read_b64_tr_b16 a[62:63], v9 offset:5120
v_cvt_pk_bf16_f32 v244, v248, v249
v_fma_f32 v252, v252, s69, -v40
v_fma_f32 v253, v253, s69, -v40
v_exp_f32 v252, v252
v_mfma_f32_32x32x16_bf16 a[96:111], a[28:31], v[228:231], a[96:111]
v_exp_f32 v253, v253
v_cvt_pk_bf16_f32 v245, v250, v251
v_fma_f32 v254, v254, s69, -v40
v_fma_f32 v255, v255, s69, -v40
v_mfma_f32_32x32x16_bf16 v[48:63], a[4:7], v[228:231], v[48:63]
v_exp_f32 v254, v254
v_exp_f32 v255, v255
v_cvt_pk_bf16_f32 v246, v252, v253
v_cvt_pk_bf16_f32 v247, v254, v255
s_waitcnt lgkmcnt(0)
v_mov_b32 v44, -1
v_mov_b32 v45, -1
v_mov_b32 v46, -1
v_mov_b32 v47, -1
s_xor_b32 s70, s66, 4096
buffer_store_dwordx4 v[44:47], v1, s[48:51], s70 offen sc1
s_xor_b32 s70, s66, 8192
buffer_store_dwordx4 v[44:47], v1, s[48:51], s70 offen sc1
s_xor_b32 s70, s66, 12288
buffer_store_dwordx4 v[44:47], v1, s[48:51], s70 offen sc1
v_mfma_f32_32x32x16_bf16 a[64:79], a[40:43], v[240:243], a[64:79]
v_mfma_f32_32x32x16_bf16 a[64:79], a[44:47], v[244:247], a[64:79]
s_add_u32 s71, s71, 15360
buffer_load_dwordx4 v27, s[36:39], s71 offen offset:2048 lds
v_mfma_f32_32x32x16_bf16 a[80:95], a[48:51], v[240:243], a[80:95]
v_mfma_f32_32x32x16_bf16 a[80:95], a[52:55], v[244:247], a[80:95]
v_mfma_f32_32x32x16_bf16 a[96:111], a[56:59], v[240:243], a[96:111]
s_add_u32 s71, s71, 15360
buffer_load_dwordx4 v27, s[36:39], s71 offen offset:3072 lds
v_mfma_f32_32x32x16_bf16 a[96:111], a[60:63], v[244:247], a[96:111]
s_nop 3
ds_write_b128 v2, a[64:67] offset:28672
ds_write_b128 v2, a[68:71] offset:29696
ds_write_b128 v2, a[72:75] offset:30720
ds_write_b128 v2, a[76:79] offset:31744
v_mfma_f32_32x32x16_bf16 a[112:127], v[124:127], v[240:243], a[112:127]
v_mfma_f32_32x32x16_bf16 a[112:127], v[124:127], v[244:247], a[112:127]
ds_write_b128 v2, a[80:83]
ds_write_b128 v2, a[84:87] offset:1024
ds_write_b128 v2, a[88:91] offset:2048
ds_write_b128 v2, a[92:95] offset:3072
s_add_u32 m0, s57, 20480
s_xor_b32 s71, s67, 196608
buffer_load_dwordx4 v27, s[36:39], s71 offen lds
v_mfma_f32_32x32x16_bf16 v[48:63], a[32:35], v[240:243], v[48:63]
s_waitcnt vmcnt(12)
ds_read_b64_tr_b16 a[136:137], v14 offset:8192
ds_read_b64_tr_b16 a[138:139], v14 offset:8704
ds_read_b64_tr_b16 a[140:141], v15 offset:8192
ds_read_b64_tr_b16 a[142:143], v15 offset:8704
ds_read_b64_tr_b16 a[144:145], v14 offset:10240
ds_read_b64_tr_b16 a[146:147], v14 offset:10752
ds_read_b64_tr_b16 a[148:149], v15 offset:10240
ds_read_b64_tr_b16 a[150:151], v15 offset:10752
v_mfma_f32_32x32x16_bf16 v[48:63], a[36:39], v[244:247], v[48:63]
ds_write_b128 v2, a[96:99] offset:12288
ds_write_b128 v2, a[100:103] offset:13312
ds_write_b128 v2, a[104:107] offset:14336
ds_write_b128 v2, a[108:111] offset:15360
v_and_b32 v37, 31, v0
v_lshlrev_b32 v37, 4, v37
s_lshl_b32 s58, s52, 2
v_add_u32 v38, s58, v37
ds_write_b32 v38, a112 offset:39424
s_waitcnt lgkmcnt(0)
s_barrier
ds_read_b128 v[44:47], v37 offset:39424
ds_read_b128 v[72:75], v3 offset:28672
ds_read_b128 v[76:79], v3 offset:29696
ds_read_b128 v[80:83], v3 offset:30720
ds_read_b128 v[84:87], v3 offset:31744
ds_read_b128 v[88:91], v4
ds_read_b128 v[92:95], v4 offset:1024
ds_read_b128 v[96:99], v4 offset:2048
ds_read_b128 v[100:103], v4 offset:3072
ds_read_b128 v[104:107], v5 offset:12288
ds_read_b128 v[108:111], v5 offset:13312
ds_read_b128 v[112:115], v5 offset:14336
ds_read_b128 v[116:119], v5 offset:15360
s_lshl_b32 s70, s73, 13
s_lshl_b32 s58, s52, 11
s_add_u32 s70, s70, s58
s_add_u32 s70, s70, 1048576
s_waitcnt lgkmcnt(12)
v_add_f32 v44, v44, v45
v_add_f32 v46, v46, v47
v_add_f32 v44, v44, v46
v_rcp_f32 v44, v44
s_waitcnt lgkmcnt(8)
v_pk_add_f32 v[48:49], v[48:49], v[72:73]
v_pk_add_f32 v[50:51], v[50:51], v[74:75]
v_pk_add_f32 v[52:53], v[52:53], v[76:77]
v_pk_add_f32 v[54:55], v[54:55], v[78:79]
v_pk_add_f32 v[56:57], v[56:57], v[80:81]
v_pk_add_f32 v[58:59], v[58:59], v[82:83]
v_pk_add_f32 v[60:61], v[60:61], v[84:85]
v_pk_add_f32 v[62:63], v[62:63], v[86:87]
s_waitcnt lgkmcnt(4)
v_pk_add_f32 v[48:49], v[48:49], v[88:89]
v_pk_add_f32 v[50:51], v[50:51], v[90:91]
v_pk_add_f32 v[52:53], v[52:53], v[92:93]
v_pk_add_f32 v[54:55], v[54:55], v[94:95]
v_pk_add_f32 v[56:57], v[56:57], v[96:97]
v_pk_add_f32 v[58:59], v[58:59], v[98:99]
v_pk_add_f32 v[60:61], v[60:61], v[100:101]
v_pk_add_f32 v[62:63], v[62:63], v[102:103]
s_waitcnt lgkmcnt(0)
v_pk_add_f32 v[48:49], v[48:49], v[104:105]
v_pk_add_f32 v[50:51], v[50:51], v[106:107]
v_pk_add_f32 v[52:53], v[52:53], v[108:109]
v_pk_add_f32 v[54:55], v[54:55], v[110:111]
v_pk_add_f32 v[56:57], v[56:57], v[112:113]
v_pk_add_f32 v[58:59], v[58:59], v[114:115]
v_pk_add_f32 v[60:61], v[60:61], v[116:117]
v_pk_add_f32 v[62:63], v[62:63], v[118:119]
v_pk_mul_f32 v[48:49], v[48:49], v[44:45] op_sel_hi:[1,0]
v_pk_mul_f32 v[50:51], v[50:51], v[44:45] op_sel_hi:[1,0]
v_pk_mul_f32 v[52:53], v[52:53], v[44:45] op_sel_hi:[1,0]
v_pk_mul_f32 v[54:55], v[54:55], v[44:45] op_sel_hi:[1,0]
v_cvt_pk_bf16_f32 v64, v48, v49
v_cvt_pk_bf16_f32 v65, v50, v51
v_cvt_pk_bf16_f32 v66, v52, v53
v_cvt_pk_bf16_f32 v67, v54, v55
buffer_store_dwordx4 v[64:67], v1, s[48:51], s70 offen sc1
v_pk_mul_f32 v[56:57], v[56:57], v[44:45] op_sel_hi:[1,0]
v_pk_mul_f32 v[58:59], v[58:59], v[44:45] op_sel_hi:[1,0]
v_pk_mul_f32 v[60:61], v[60:61], v[44:45] op_sel_hi:[1,0]
v_pk_mul_f32 v[62:63], v[62:63], v[44:45] op_sel_hi:[1,0]
v_cvt_pk_bf16_f32 v68, v56, v57
v_cvt_pk_bf16_f32 v69, v58, v59
v_cvt_pk_bf16_f32 v70, v60, v61
v_cvt_pk_bf16_f32 v71, v62, v63
buffer_store_dwordx4 v[68:71], v1, s[48:51], s70 offen offset:1024 sc1
s_waitcnt vmcnt(10)
ds_read_b64_tr_b16 a[152:153], v14 offset:16384
ds_read_b64_tr_b16 a[154:155], v14 offset:16896
ds_read_b64_tr_b16 a[156:157], v15 offset:16384
ds_read_b64_tr_b16 a[158:159], v15 offset:16896
ds_read_b64_tr_b16 a[160:161], v14 offset:18432
ds_read_b64_tr_b16 a[162:163], v14 offset:18944
ds_read_b64_tr_b16 a[164:165], v15 offset:18432
ds_read_b64_tr_b16 a[166:167], v15 offset:18944
s_waitcnt vmcnt(3)
ds_read_b64_tr_b16 a[168:169], v14 offset:24576
ds_read_b64_tr_b16 a[170:171], v14 offset:25088
ds_read_b64_tr_b16 a[172:173], v15 offset:24576
ds_read_b64_tr_b16 a[174:175], v15 offset:25088
ds_read_b64_tr_b16 a[176:177], v14 offset:26624
ds_read_b64_tr_b16 a[178:179], v14 offset:27136
ds_read_b64_tr_b16 a[180:181], v15 offset:26624
ds_read_b64_tr_b16 a[182:183], v15 offset:27136
s_add_u32 s71, s71, 15360
buffer_load_dwordx4 v27, s[36:39], s71 offen offset:1024 lds
s_add_u32 s71, s71, 15360
buffer_load_dwordx4 v27, s[36:39], s71 offen offset:2048 lds
s_add_u32 s71, s71, 15360
buffer_load_dwordx4 v27, s[36:39], s71 offen offset:3072 lds
s_add_u32 m0, s57, 32768
s_xor_b32 s71, s67, 262144
buffer_load_dwordx4 v27, s[36:39], s71 offen lds
s_waitcnt vmcnt(4)
s_barrier
s_cmp_lg_u32 s52, 0
s_cbranch_scc1 L_noflag
v_mov_b32 v36, s74
v_mov_b32 v37, 1
s_mov_b64 exec, 1
buffer_atomic_add v37, v36, s[48:51], 0 offen
s_mov_b64 exec, -1
L_noflag:
s_add_u32 s71, s71, 15360
buffer_load_dwordx4 v27, s[36:39], s71 offen offset:1024 lds
s_add_u32 s71, s71, 15360
buffer_load_dwordx4 v27, s[36:39], s71 offen offset:2048 lds
s_add_u32 s71, s71, 15360
buffer_load_dwordx4 v27, s[36:39], s71 offen offset:3072 lds
s_add_u32 m0, s57, 4096
s_xor_b32 s71, s67, 327680
buffer_load_dwordx4 v27, s[36:39], s71 offen lds
s_add_u32 s71, s71, 15360
buffer_load_dwordx4 v27, s[36:39], s71 offen offset:1024 lds
s_add_u32 s71, s71, 15360
buffer_load_dwordx4 v27, s[36:39], s71 offen offset:2048 lds
s_add_u32 s71, s71, 15360
buffer_load_dwordx4 v27, s[36:39], s71 offen offset:3072 lds
s_add_u32 m0, s57, 8192
s_xor_b32 s71, s67, 393216
buffer_load_dwordx4 v27, s[36:39], s71 offen lds
s_add_u32 s71, s71, 15360
buffer_load_dwordx4 v27, s[36:39], s71 offen offset:1024 lds
s_add_u32 s71, s71, 15360
buffer_load_dwordx4 v27, s[36:39], s71 offen offset:2048 lds
s_add_u32 s71, s71, 15360
buffer_load_dwordx4 v27, s[36:39], s71 offen offset:3072 lds
s_add_u32 m0, s57, 28672
s_xor_b32 s71, s67, 458752
buffer_load_dwordx4 v27, s[36:39], s71 offen lds
s_add_u32 s71, s71, 15360
buffer_load_dwordx4 v27, s[36:39], s71 offen offset:1024 lds
s_add_u32 s71, s71, 15360
buffer_load_dwordx4 v27, s[36:39], s71 offen offset:2048 lds
s_add_u32 s71, s71, 15360
buffer_load_dwordx4 v27, s[36:39], s71 offen offset:3072 lds
s_waitcnt vmcnt(16)
ds_read_b64_tr_b16 a[184:185], v14 offset:20480
ds_read_b64_tr_b16 a[186:187], v14 offset:20992
ds_read_b64_tr_b16 a[188:189], v15 offset:20480
ds_read_b64_tr_b16 a[190:191], v15 offset:20992
ds_read_b64_tr_b16 a[192:193], v14 offset:22528
ds_read_b64_tr_b16 a[194:195], v14 offset:23040
ds_read_b64_tr_b16 a[196:197], v15 offset:22528
ds_read_b64_tr_b16 a[198:199], v15 offset:23040
s_waitcnt vmcnt(12)
ds_read_b64_tr_b16 a[200:201], v14 offset:32768
ds_read_b64_tr_b16 a[202:203], v14 offset:33280
ds_read_b64_tr_b16 a[204:205], v15 offset:32768
ds_read_b64_tr_b16 a[206:207], v15 offset:33280
ds_read_b64_tr_b16 a[208:209], v14 offset:34816
ds_read_b64_tr_b16 a[210:211], v14 offset:35328
ds_read_b64_tr_b16 a[212:213], v15 offset:34816
ds_read_b64_tr_b16 a[214:215], v15 offset:35328
s_waitcnt lgkmcnt(15)
s_waitcnt lgkmcnt(8)
s_waitcnt lgkmcnt(0)
s_waitcnt vmcnt(8)
ds_read_b64_tr_b16 a[216:217], v14 offset:4096
ds_read_b64_tr_b16 a[218:219], v14 offset:4608
ds_read_b64_tr_b16 a[220:221], v15 offset:4096
ds_read_b64_tr_b16 a[222:223], v15 offset:4608
ds_read_b64_tr_b16 a[224:225], v14 offset:6144
ds_read_b64_tr_b16 a[226:227], v14 offset:6656
ds_read_b64_tr_b16 a[228:229], v15 offset:6144
ds_read_b64_tr_b16 a[230:231], v15 offset:6656
s_waitcnt lgkmcnt(0)
s_lshl_b32 s58, s14, 4
s_lshl_b32 s59, s55, 2
s_add_u32 s58, s58, s59
s_add_u32 s58, s58, s52
s_lshl_b32 s58, s58, 7
s_xor_b32 s59, s58, 2048
v_mov_b32 v36, s58
v_writelane_b32 v36, s59, 1
s_mov_b32 s72, 400000
s_mov_b64 exec, 3
L_poll:
s_nop 0
buffer_load_dword v39, v36, s[48:51], 0 offen sc1
s_waitcnt vmcnt(0)
v_cmp_ne_u32 vcc, 2, v39
s_cbranch_vccz L_pollok
s_sleep 4
s_sub_u32 s72, s72, 1
s_cmp_eq_u32 s72, 0
s_cbranch_scc0 L_poll
L_pollok:
s_mov_b64 exec, -1
s_xor_b32 s71, s68, 0
buffer_load_dwordx4 v[128:131], v1, s[48:51], s71 offen sc1
buffer_load_dwordx4 v[136:139], v1, s[48:51], s71 offen offset:1024 sc1
s_xor_b32 s71, s11, 0
buffer_load_dwordx4 v[132:135], v1, s[48:51], s71 offen sc1
buffer_load_dwordx4 v[140:143], v1, s[48:51], s71 offen offset:1024 sc1
s_xor_b32 s71, s68, 2048
buffer_load_dwordx4 v[144:147], v1, s[48:51], s71 offen sc1
buffer_load_dwordx4 v[152:155], v1, s[48:51], s71 offen offset:1024 sc1
s_xor_b32 s71, s11, 2048
buffer_load_dwordx4 v[148:151], v1, s[48:51], s71 offen sc1
buffer_load_dwordx4 v[156:159], v1, s[48:51], s71 offen offset:1024 sc1
s_xor_b32 s71, s68, 4096
buffer_load_dwordx4 v[160:163], v1, s[48:51], s71 offen sc1
buffer_load_dwordx4 v[168:171], v1, s[48:51], s71 offen offset:1024 sc1
s_xor_b32 s71, s11, 4096
buffer_load_dwordx4 v[164:167], v1, s[48:51], s71 offen sc1
buffer_load_dwordx4 v[172:175], v1, s[48:51], s71 offen offset:1024 sc1
ds_read_b64_tr_b16 a[32:33], v14 offset:8192
ds_read_b64_tr_b16 a[34:35], v14 offset:8704
ds_read_b64_tr_b16 a[36:37], v15 offset:8192
ds_read_b64_tr_b16 a[38:39], v15 offset:8704
ds_read_b64_tr_b16 a[40:41], v14 offset:10240
ds_read_b64_tr_b16 a[42:43], v14 offset:10752
ds_read_b64_tr_b16 a[44:45], v15 offset:10240
ds_read_b64_tr_b16 a[46:47], v15 offset:10752
ds_read_b64_tr_b16 a[48:49], v14 offset:28672
ds_read_b64_tr_b16 a[50:51], v14 offset:29184
ds_read_b64_tr_b16 a[52:53], v15 offset:28672
ds_read_b64_tr_b16 a[54:55], v15 offset:29184
ds_read_b64_tr_b16 a[56:57], v14 offset:30720
ds_read_b64_tr_b16 a[58:59], v14 offset:31232
ds_read_b64_tr_b16 a[60:61], v15 offset:30720
ds_read_b64_tr_b16 a[62:63], v15 offset:31232
v_and_b32 v37, 31, v0
v_lshlrev_b32 v37, 11, v37
v_lshrrev_b32 v38, 5, v0
v_lshl_add_u32 v37, v38, 4, v37
s_waitcnt vmcnt(9)
v_mfma_f32_32x32x16_bf16 v[104:119], a[140:143], v[132:135], 0
s_xor_b32 s71, s68, 6144
buffer_load_dwordx4 v[176:179], v1, s[48:51], s71 offen sc1
v_mfma_f32_32x32x16_bf16 v[88:103], a[136:139], v[132:135], 0
buffer_load_dwordx4 v[184:187], v1, s[48:51], s71 offen offset:1024 sc1
s_waitcnt vmcnt(10)
v_mfma_f32_32x32x16_bf16 v[104:119], a[148:151], v[140:143], v[104:119]
s_xor_b32 s71, s11, 6144
buffer_load_dwordx4 v[180:183], v1, s[48:51], s71 offen sc1
v_mfma_f32_32x32x16_bf16 v[88:103], a[144:147], v[140:143], v[88:103]
buffer_load_dwordx4 v[188:191], v1, s[48:51], s71 offen offset:1024 sc1
v_mfma_f32_32x32x16_bf16 v[72:87], a[140:143], v[128:131], 0
s_xor_b32 s71, s68, 8192
buffer_load_dwordx4 v[192:195], v1, s[48:51], s71 offen sc1
v_mfma_f32_32x32x16_bf16 v[48:63], a[136:139], v[128:131], 0
buffer_load_dwordx4 v[200:203], v1, s[48:51], s71 offen offset:1024 sc1
v_mfma_f32_32x32x16_bf16 v[72:87], a[148:151], v[136:139], v[72:87]
s_xor_b32 s71, s11, 8192
buffer_load_dwordx4 v[196:199], v1, s[48:51], s71 offen sc1
v_mfma_f32_32x32x16_bf16 v[48:63], a[144:147], v[136:139], v[48:63]
buffer_load_dwordx4 v[204:207], v1, s[48:51], s71 offen offset:1024 sc1
s_waitcnt vmcnt(13)
v_mfma_f32_32x32x16_bf16 v[104:119], a[156:159], v[148:151], v[104:119]
s_xor_b32 s71, s68, 10240
buffer_load_dwordx4 v[208:211], v1, s[48:51], s71 offen sc1
v_mfma_f32_32x32x16_bf16 v[88:103], a[152:155], v[148:151], v[88:103]
buffer_load_dwordx4 v[216:219], v1, s[48:51], s71 offen offset:1024 sc1
s_waitcnt vmcnt(14)
v_mfma_f32_32x32x16_bf16 v[104:119], a[164:167], v[156:159], v[104:119]
s_xor_b32 s71, s11, 10240
buffer_load_dwordx4 v[212:215], v1, s[48:51], s71 offen sc1
v_mfma_f32_32x32x16_bf16 v[88:103], a[160:163], v[156:159], v[88:103]
buffer_load_dwordx4 v[220:223], v1, s[48:51], s71 offen offset:1024 sc1
v_mfma_f32_32x32x16_bf16 v[72:87], a[156:159], v[144:147], v[72:87]
s_xor_b32 s71, s68, 12288
buffer_load_dwordx4 v[224:227], v1, s[48:51], s71 offen sc1
v_mfma_f32_32x32x16_bf16 v[48:63], a[152:155], v[144:147], v[48:63]
buffer_load_dwordx4 v[232:235], v1, s[48:51], s71 offen offset:1024 sc1
v_mfma_f32_32x32x16_bf16 v[72:87], a[164:167], v[152:155], v[72:87]
s_xor_b32 s71, s11, 12288
buffer_load_dwordx4 v[228:231], v1, s[48:51], s71 offen sc1
v_mfma_f32_32x32x16_bf16 v[48:63], a[160:163], v[152:155], v[48:63]
buffer_load_dwordx4 v[236:239], v1, s[48:51], s71 offen offset:1024 sc1
s_waitcnt vmcnt(17)
v_mfma_f32_32x32x16_bf16 v[104:119], a[172:175], v[164:167], v[104:119]
s_xor_b32 s71, s68, 14336
buffer_load_dwordx4 v[240:243], v1, s[48:51], s71 offen sc1
v_mfma_f32_32x32x16_bf16 v[88:103], a[168:171], v[164:167], v[88:103]
buffer_load_dwordx4 v[248:251], v1, s[48:51], s71 offen offset:1024 sc1
s_waitcnt vmcnt(18)
v_mfma_f32_32x32x16_bf16 v[104:119], a[180:183], v[172:175], v[104:119]
s_xor_b32 s71, s11, 14336
buffer_load_dwordx4 v[244:247], v1, s[48:51], s71 offen sc1
v_mfma_f32_32x32x16_bf16 v[88:103], a[176:179], v[172:175], v[88:103]
buffer_load_dwordx4 v[252:255], v1, s[48:51], s71 offen offset:1024 sc1
v_mfma_f32_32x32x16_bf16 v[72:87], a[172:175], v[160:163], v[72:87]
v_mfma_f32_32x32x16_bf16 v[48:63], a[168:171], v[160:163], v[48:63]
v_mfma_f32_32x32x16_bf16 v[72:87], a[180:183], v[168:171], v[72:87]
v_mfma_f32_32x32x16_bf16 v[48:63], a[176:179], v[168:171], v[48:63]
s_waitcnt vmcnt(17)
v_mfma_f32_32x32x16_bf16 v[104:119], a[188:191], v[180:183], v[104:119]
v_mfma_f32_32x32x16_bf16 v[88:103], a[184:187], v[180:183], v[88:103]
s_waitcnt vmcnt(16)
v_mfma_f32_32x32x16_bf16 v[104:119], a[196:199], v[188:191], v[104:119]
v_mfma_f32_32x32x16_bf16 v[88:103], a[192:195], v[188:191], v[88:103]
v_mfma_f32_32x32x16_bf16 v[72:87], a[188:191], v[176:179], v[72:87]
v_mfma_f32_32x32x16_bf16 v[48:63], a[184:187], v[176:179], v[48:63]
v_mfma_f32_32x32x16_bf16 v[72:87], a[196:199], v[184:187], v[72:87]
v_mfma_f32_32x32x16_bf16 v[48:63], a[192:195], v[184:187], v[48:63]
s_waitcnt vmcnt(13)
v_mfma_f32_32x32x16_bf16 v[104:119], a[204:207], v[196:199], v[104:119]
v_mfma_f32_32x32x16_bf16 v[88:103], a[200:203], v[196:199], v[88:103]
s_waitcnt vmcnt(12)
v_mfma_f32_32x32x16_bf16 v[104:119], a[212:215], v[204:207], v[104:119]
v_mfma_f32_32x32x16_bf16 v[88:103], a[208:211], v[204:207], v[88:103]
v_mfma_f32_32x32x16_bf16 v[72:87], a[204:207], v[192:195], v[72:87]
v_mfma_f32_32x32x16_bf16 v[48:63], a[200:203], v[192:195], v[48:63]
v_mfma_f32_32x32x16_bf16 v[72:87], a[212:215], v[200:203], v[72:87]
v_mfma_f32_32x32x16_bf16 v[48:63], a[208:211], v[200:203], v[48:63]
s_waitcnt vmcnt(9)
v_mfma_f32_32x32x16_bf16 v[104:119], a[220:223], v[212:215], v[104:119]
v_mfma_f32_32x32x16_bf16 v[88:103], a[216:219], v[212:215], v[88:103]
s_waitcnt vmcnt(8)
v_mfma_f32_32x32x16_bf16 v[104:119], a[228:231], v[220:223], v[104:119]
v_mfma_f32_32x32x16_bf16 v[88:103], a[224:227], v[220:223], v[88:103]
v_mfma_f32_32x32x16_bf16 v[72:87], a[220:223], v[208:211], v[72:87]
v_mfma_f32_32x32x16_bf16 v[48:63], a[216:219], v[208:211], v[48:63]
v_mfma_f32_32x32x16_bf16 v[72:87], a[228:231], v[216:219], v[72:87]
v_mfma_f32_32x32x16_bf16 v[48:63], a[224:227], v[216:219], v[48:63]
v_lshlrev_b32 v32, 9, v0
v_xor_b32 v32, s74, v32
s_mov_b64 exec, 14
buffer_load_dword v33, v32, s[48:51], 0 offen sc1
s_mov_b64 exec, -1
s_waitcnt lgkmcnt(8)
s_waitcnt vmcnt(6)
v_mfma_f32_32x32x16_bf16 v[104:119], a[36:39], v[228:231], v[104:119]
v_mfma_f32_32x32x16_bf16 v[88:103], a[32:35], v[228:231], v[88:103]
s_waitcnt vmcnt(5)
v_mfma_f32_32x32x16_bf16 v[104:119], a[44:47], v[236:239], v[104:119]
v_mfma_f32_32x32x16_bf16 v[88:103], a[40:43], v[236:239], v[88:103]
v_mfma_f32_32x32x16_bf16 v[72:87], a[36:39], v[224:227], v[72:87]
v_mfma_f32_32x32x16_bf16 v[48:63], a[32:35], v[224:227], v[48:63]
v_mfma_f32_32x32x16_bf16 v[72:87], a[44:47], v[232:235], v[72:87]
v_mfma_f32_32x32x16_bf16 v[48:63], a[40:43], v[232:235], v[48:63]
s_waitcnt lgkmcnt(0)
s_waitcnt vmcnt(2)
v_mfma_f32_32x32x16_bf16 v[104:119], a[52:55], v[244:247], v[104:119]
v_mfma_f32_32x32x16_bf16 v[88:103], a[48:51], v[244:247], v[88:103]
s_waitcnt vmcnt(1)
v_mfma_f32_32x32x16_bf16 v[104:119], a[60:63], v[252:255], v[104:119]
v_mfma_f32_32x32x16_bf16 v[88:103], a[56:59], v[252:255], v[88:103]
v_mfma_f32_32x32x16_bf16 v[72:87], a[52:55], v[240:243], v[72:87]
v_mfma_f32_32x32x16_bf16 v[72:87], a[60:63], v[248:251], v[72:87]
s_nop 8
ds_write_b128 v2, v[108:111] offset:24576
ds_write_b128 v2, v[112:115] offset:25600
ds_write_b128 v2, v[116:119] offset:26624
ds_write_b128 v2, v[92:95] offset:16384
ds_write_b128 v2, v[96:99] offset:17408
ds_write_b128 v2, v[100:103] offset:18432
ds_write_b128 v2, v[76:79] offset:12288
ds_write_b128 v2, v[80:83] offset:13312
ds_write_b128 v2, v[84:87] offset:14336
s_cmp_lg_u32 s52, 0
s_cbranch_scc1 L_ordskip
s_mov_b32 s72, 400000
s_mov_b64 exec, 14
L_ord:
s_waitcnt vmcnt(0)
v_cmp_ne_u32 vcc, 2, v33
s_cbranch_vccz L_ordok
s_sleep 2
buffer_load_dword v33, v32, s[48:51], 0 offen sc1
s_sub_u32 s72, s72, 1
s_cmp_eq_u32 s72, 0
s_cbranch_scc0 L_ord
L_ordok:
s_mov_b64 exec, -1
L_ordskip:
s_waitcnt lgkmcnt(0)
s_barrier
ds_read_b128 v[180:183], v3 offset:24576
ds_read_b128 v[184:187], v4 offset:25600
ds_read_b128 v[188:191], v5 offset:26624
ds_read_b128 v[164:167], v3 offset:16384
ds_read_b128 v[168:171], v4 offset:17408
ds_read_b128 v[172:175], v5 offset:18432
ds_read_b128 v[148:151], v3 offset:12288
ds_read_b128 v[152:155], v4 offset:13312
ds_read_b128 v[156:159], v5 offset:14336
v_mfma_f32_32x32x16_bf16 v[48:63], a[48:51], v[240:243], v[48:63]
v_mfma_f32_32x32x16_bf16 v[48:63], a[56:59], v[248:251], v[48:63]
s_waitcnt lgkmcnt(7)
v_pk_add_f32 v[180:181], v[180:181], v[184:185]
v_pk_add_f32 v[182:183], v[182:183], v[186:187]
s_waitcnt lgkmcnt(6)
v_pk_add_f32 v[188:189], v[188:189], v[104:105]
v_pk_add_f32 v[190:191], v[190:191], v[106:107]
v_pk_add_f32 v[104:105], v[180:181], v[188:189]
v_pk_add_f32 v[106:107], v[182:183], v[190:191]
v_min_u32 v104, -2, v104
v_min_u32 v105, -2, v105
v_min_u32 v106, -2, v106
v_min_u32 v107, -2, v107
s_xor_b32 s70, s66, 405504
buffer_store_dwordx4 v[104:107], v1, s[48:51], s70 offen sc1
s_waitcnt lgkmcnt(4)
v_pk_add_f32 v[164:165], v[164:165], v[168:169]
v_pk_add_f32 v[166:167], v[166:167], v[170:171]
s_waitcnt lgkmcnt(3)
v_pk_add_f32 v[172:173], v[172:173], v[88:89]
v_pk_add_f32 v[174:175], v[174:175], v[90:91]
v_pk_add_f32 v[88:89], v[164:165], v[172:173]
v_pk_add_f32 v[90:91], v[166:167], v[174:175]
v_min_u32 v88, -2, v88
v_min_u32 v89, -2, v89
v_min_u32 v90, -2, v90
v_min_u32 v91, -2, v91
s_xor_b32 s70, s66, 270336
buffer_store_dwordx4 v[88:91], v1, s[48:51], s70 offen sc1
s_waitcnt lgkmcnt(1)
v_pk_add_f32 v[148:149], v[148:149], v[152:153]
v_pk_add_f32 v[150:151], v[150:151], v[154:155]
s_waitcnt lgkmcnt(0)
v_pk_add_f32 v[156:157], v[156:157], v[72:73]
v_pk_add_f32 v[158:159], v[158:159], v[74:75]
v_pk_add_f32 v[72:73], v[148:149], v[156:157]
v_pk_add_f32 v[74:75], v[150:151], v[158:159]
v_min_u32 v72, -2, v72
v_min_u32 v73, -2, v73
v_min_u32 v74, -2, v74
v_min_u32 v75, -2, v75
s_xor_b32 s70, s66, 135168
buffer_store_dwordx4 v[72:75], v1, s[48:51], s70 offen sc1
ds_write_b128 v2, v[52:55]
ds_write_b128 v2, v[56:59] offset:1024
ds_write_b128 v2, v[60:63] offset:2048
s_waitcnt lgkmcnt(0)
s_barrier
ds_read_b128 v[132:135], v3
ds_read_b128 v[136:139], v4 offset:1024
ds_read_b128 v[140:143], v5 offset:2048
s_waitcnt lgkmcnt(1)
v_pk_add_f32 v[132:133], v[132:133], v[136:137]
v_pk_add_f32 v[134:135], v[134:135], v[138:139]
s_waitcnt lgkmcnt(0)
v_pk_add_f32 v[140:141], v[140:141], v[48:49]
v_pk_add_f32 v[142:143], v[142:143], v[50:51]
v_pk_add_f32 v[48:49], v[132:133], v[140:141]
v_pk_add_f32 v[50:51], v[134:135], v[142:143]
s_mov_b32 s72, 400000
s_xor_b32 s58, s66, 4096
s_xor_b32 s59, s66, 8192
s_xor_b32 s60, s66, 12288
L_xp:
s_sleep 2
buffer_load_dwordx4 v[192:195], v1, s[48:51], s58 offen sc1
buffer_load_dwordx4 v[196:199], v1, s[48:51], s59 offen sc1
buffer_load_dwordx4 v[200:203], v1, s[48:51], s60 offen sc1
s_waitcnt vmcnt(0)
v_max3_u32 v31, v192, v193, v194
v_max3_u32 v32, v195, v196, v197
v_max3_u32 v33, v198, v199, v200
v_max3_u32 v34, v201, v202, v203
v_max3_u32 v31, v31, v32, v33
v_max_u32 v31, v31, v34
v_cmp_eq_u32 vcc, -1, v31
s_cbranch_vccz L_xok

s_sub_u32 s72, s72, 1
s_cmp_eq_u32 s72, 0
s_cbranch_scc0 L_xp
L_xok:
v_pk_add_f32 v[192:193], v[192:193], v[196:197]
v_pk_add_f32 v[194:195], v[194:195], v[198:199]
v_pk_add_f32 v[48:49], v[48:49], v[200:201]
v_pk_add_f32 v[50:51], v[50:51], v[202:203]
v_pk_add_f32 v[48:49], v[48:49], v[192:193]
v_pk_add_f32 v[50:51], v[50:51], v[194:195]
v_cvt_pk_bf16_f32 v48, v48, v49
v_cvt_pk_bf16_f32 v49, v50, v51
buffer_store_dwordx2 v[48:49], v37, s[40:43], s65 offen
L_end:
s_endpgm
.fill 640, 4, 0xbf800000
.section .rodata,"a"
.p2align 6
.amdhsa_kernel standalone__gqa_block_cached__near_ridge_kernel
  .amdhsa_next_free_vgpr 512
  .amdhsa_next_free_sgpr 102
  .amdhsa_accum_offset 256
  .amdhsa_group_segment_fixed_size 0
  .amdhsa_kernarg_size 64
  .amdhsa_user_sgpr_count 2
  .amdhsa_user_sgpr_kernarg_segment_ptr 1
  .amdhsa_system_sgpr_workgroup_id_x 1
  .amdhsa_float_denorm_mode_32 3
.end_amdhsa_kernel
```
